```python
import torch

def _softmax(x, axis=-1):
    return torch.softmax(x, dim=axis)
def _gelu(x):
    return torch.nn.functional.gelu(x, approximate="tanh")
def _silu(x):
    return torch.nn.functional.silu(x)
def _sigmoid(x):
    return torch.sigmoid(x)
def _layernorm(x, axis=-1, eps=1e-5):
    m = x.mean(dim=axis, keepdim=True)
    v = x.var(dim=axis, keepdim=True, unbiased=False)
    return (x - m) / torch.sqrt(v + eps)
def _scatter_add(tgt, idx, src, axis=0):
    return tgt.clone().index_add_(axis, idx, src)
def _segment_sum(src, seg, n):
    out = torch.zeros((n,) + src.shape[1:], dtype=src.dtype)
    return out.index_add_(0, seg, src)
def _pad(x, pw):
    flat = tuple(v for pair in reversed(pw) for v in pair)
    return torch.nn.functional.pad(x, flat)

kernel_name = 'parallel_sum__ssm_conv_s4d__glu_gated_swiglu__prompt'

def setup_inputs():

    _w = (lambda a: (lambda t: t.to(torch.bfloat16) if t.is_floating_point() else t)(torch.as_tensor(a)))
    def _A_setup():
        Bsz, L, D, N = 1, 2048, 640, 192
        return {
            "u": _w((lambda *s: torch.randn(*s, dtype=torch.bfloat16) * 0.05)(Bsz, L, D)),
            "log_A_real": _w((lambda *s: torch.randn(*s, dtype=torch.bfloat16) * 3.2)(D, N) * 0.5),
            "A_imag": _w((lambda *s: torch.randn(*s, dtype=torch.bfloat16) * 0.05)(D, N) * 3.14),
            "C_real": _w((lambda *s: torch.randn(*s, dtype=torch.bfloat16) * 0.2)(D, N) / N ** 0.5),
            "C_imag": _w((lambda *s: torch.randn(*s, dtype=torch.bfloat16) * 0.2)(D, N) / N ** 0.5),
            "log_dt": _w((lambda *s: torch.randn(*s, dtype=torch.bfloat16) * 0.05)(D) * 0.5 - 4.0),
            "D_skip": _w((lambda *s: torch.randn(*s, dtype=torch.bfloat16) * 0.05)(D)),
        }
    _A_in = _A_setup()

    def _B_setup():
        B, S, D, F = 1, 2048, 640, 1536
        return {
            "x": _w((lambda *s: torch.randn(*s, dtype=torch.bfloat16) * 0.05)(B, S, D)),
            "w1": _w((lambda *s: torch.randn(*s, dtype=torch.bfloat16) * 0.4)(D, F) * (2.0 / D) ** 0.5),
            "w3": _w((lambda *s: torch.randn(*s, dtype=torch.bfloat16) * 0.4)(D, F) * (2.0 / D) ** 0.5),
            "w2": _w((lambda *s: torch.randn(*s, dtype=torch.bfloat16) * 0.4)(F, D) * (2.0 / F) ** 0.5),
        }
    _B_in = _B_setup()

    return {
        "A_u": _A_in["u"],
        "A_log_A_real": _A_in["log_A_real"],
        "A_A_imag": _A_in["A_imag"],
        "A_C_real": _A_in["C_real"],
        "A_C_imag": _A_in["C_imag"],
        "A_log_dt": _A_in["log_dt"],
        "A_D_skip": _A_in["D_skip"],
        "B_x": _B_in["x"],
        "B_w1": _B_in["w1"],
        "B_w3": _B_in["w3"],
        "B_w2": _B_in["w2"],
    }

def reference(A_u, A_log_A_real, A_A_imag, A_C_real, A_C_imag, A_log_dt, A_D_skip, B_x, B_w1, B_w3, B_w2):
    def _A_ref(u, log_A_real, A_imag, C_real, C_imag, log_dt, D_skip):
        L = u.shape[1]
        dt = torch.exp(log_dt)
        A = -torch.exp(log_A_real) + 1j * A_imag
        C = (C_real + 1j * C_imag) * dt[:, None]
        pos = (lambda x, dt: x.to(dt))(torch.arange(L), log_dt.dtype)
        P = torch.exp((A * dt[:, None])[:, :, None] * pos[None, None, :])
        K = 2.0 * torch.einsum("dn,dnl->dl", C, P).real
        L2 = 2 * L
        u_t = (lambda x, *d: x.permute(*d))(u, 0, 2, 1)
        Kf = (lambda x, *a, **k: torch.fft.rfft(x.float(), *a, **k))(K, L2)
        Uf = (lambda x, *a, **k: torch.fft.rfft(x.float(), *a, **k))(u_t, L2)
        y = (lambda x, *a, **k: torch.fft.irfft(x, *a, **k).to(torch.bfloat16))(Uf * Kf[None, :, :], L2)[:, :, :L]
        y = (lambda x, *d: x.permute(*d))(y, 0, 2, 1)
        return y + u * D_skip[None, None, :]

    def _B_ref(x, w1, w3, w2):
        gate = torch.einsum("bsd,df->bsf", x, w1)
        up = torch.einsum("bsd,df->bsf", x, w3)
        h = _silu(gate) * up
        out = torch.einsum("bsf,fd->bsd", h, w2)
        return out

    x = A_u
    xn = _layernorm(x, axis=-1)
    return x + _A_ref(xn, A_log_A_real, A_A_imag, A_C_real, A_C_imag, A_log_dt, A_D_skip) + _B_ref(xn, B_w1, B_w3, B_w2)
```

```asm
; @launch grid=(512,1,1) block=(256,1,1) lds=81920
.amdgcn_target "amdgcn-amd-amdhsa--gfx950"
.text
.globl parallel_sum__ssm_conv_s4d__glu_gated_swiglu__prompt_kernel
.p2align 8
.type parallel_sum__ssm_conv_s4d__glu_gated_swiglu__prompt_kernel,@function
parallel_sum__ssm_conv_s4d__glu_gated_swiglu__prompt_kernel:
  s_cmp_ge_u32 s2, 512
  s_cbranch_scc1 Lend
  s_load_dwordx16 s[4:19], s[0:1], 0
  s_load_dwordx8 s[20:27], s[0:1], 64
  s_load_dwordx4 s[28:31], s[0:1], 96
  s_getpc_b64 s[100:101]
Lpcbase:
  s_lshr_b32 s41, s2, 3
  s_mul_i32 s41, s41, ((Lcode_end-Lpcbase+8191)/8192)
  v_add_u32 v1, s41, v0
  v_lshlrev_b32 v1, 7, v1
  v_cmp_gt_u32 vcc, ((Lcode_end-Lpcbase+8191)/8192), v0
  s_and_saveexec_b64 s[42:43], vcc
  s_cbranch_execz Lct_1
  v_min_u32 v1, (Lcode_end-Lpcbase-4), v1
  v_and_b32 v1, 0xfffffffc, v1
  global_load_dword v255, v1, s[100:101]
Lct_1:
  s_mov_b64 exec, s[42:43]
  s_cmp_ge_u32 s2, 416
  s_cbranch_scc1 Laux
  s_cmp_ge_u32 s2, 256
  s_cbranch_scc1 Lnotgemm
  s_setprio 2
  s_and_b32 s64, s2, 7
  s_lshr_b32 s61, s2, 3
  s_and_b32 s48, s61, 7
  s_lshr_b32 s49, s61, 3
  s_lshr_b32 s46, s64, 2
  s_lshl_b32 s46, s46, 3
  s_add_u32 s46, s46, s48
  s_and_b32 s47, s64, 3
  s_lshl_b32 s47, s47, 2
  s_add_u32 s47, s47, s49
  v_and_b32 v1, 63, v0
  v_lshrrev_b32 v2, 6, v0
  s_nop 0
  v_readfirstlane_b32 s56, v2
  s_nop 3
  s_cmp_lt_u32 s56, 2
  s_cselect_b32 s63, 0, 10
  s_and_b32 s61, s56, 1
  s_mul_i32 s61, s61, 192
  v_add_u32 v2, s61, v1
  v_mul_u32_u24 v3, 5462, v2
  v_lshrrev_b32 v3, 16, v3
  v_mul_u32_u24 v4, 12, v3
  v_sub_u32 v2, v2, v4
  v_add_u32 v2, s63, v2
  v_subrev_u32 v4, 12, v2
  v_cmp_le_u32 vcc, 12, v2
  s_nop 1
  v_cndmask_b32 v2, v2, v4, vcc
  v_mul_u32_u24 v3, 3072, v3
  v_lshl_add_u32 v4, v2, 4, v3
  v_add_u32 v2, s61, v1
  v_add_u32 v2, 64, v2
  v_mul_u32_u24 v3, 5462, v2
  v_lshrrev_b32 v3, 16, v3
  v_mul_u32_u24 v5, 12, v3
  v_sub_u32 v2, v2, v5
  v_add_u32 v2, s63, v2
  v_subrev_u32 v5, 12, v2
  v_cmp_le_u32 vcc, 12, v2
  s_nop 1
  v_cndmask_b32 v2, v2, v5, vcc
  v_mul_u32_u24 v3, 3072, v3
  v_lshl_add_u32 v5, v2, 4, v3
  v_subrev_u32 v5, 1024, v5
  v_add_u32 v2, s61, v1
  v_add_u32 v2, 128, v2
  v_mul_u32_u24 v3, 5462, v2
  v_lshrrev_b32 v3, 16, v3
  v_mul_u32_u24 v6, 12, v3
  v_sub_u32 v2, v2, v6
  v_add_u32 v2, s63, v2
  v_subrev_u32 v6, 12, v2
  v_cmp_le_u32 vcc, 12, v2
  s_nop 1
  v_cndmask_b32 v2, v2, v6, vcc
  v_mul_u32_u24 v3, 3072, v3
  v_lshl_add_u32 v6, v2, 4, v3
  v_subrev_u32 v6, 2048, v6
  s_mul_i32 s57, s47, 192
  s_mul_i32 s59, s56, 3072
  s_lshr_b32 s61, s48, 2
  s_add_u32 s51, s48, s61
  s_mul_i32 s61, s49, 5
  s_lshr_b32 s61, s61, 1
  s_add_u32 s51, s51, s61
  s_cmp_ge_u32 s51, 10
  s_cselect_b32 s61, 10, 0
  s_sub_u32 s51, s51, s61
  s_add_u32 s75, s57, 1966080
  s_mul_i32 s61, s51, 196608
  s_add_u32 s57, s57, s61
  v_lshrrev_b32 v2, 3, v1
  v_mul_u32_u24 v7, 1280, v2
  v_bfe_u32 v2, v2, 1, 3
  v_and_b32 v3, 7, v1
  v_xor_b32 v2, v2, v3
  v_lshl_add_u32 v7, v2, 4, v7
  v_lshrrev_b32 v2, 3, v1
  v_add_u32 v2, 8, v2
  v_mul_u32_u24 v8, 1280, v2
  v_bfe_u32 v2, v2, 1, 3
  v_and_b32 v3, 7, v1
  v_xor_b32 v2, v2, v3
  v_lshl_add_u32 v8, v2, 4, v8
  v_subrev_u32 v8, 1024, v8
  v_lshrrev_b32 v2, 3, v1
  v_add_u32 v2, 16, v2
  v_mul_u32_u24 v9, 1280, v2
  v_bfe_u32 v2, v2, 1, 3
  v_and_b32 v3, 7, v1
  v_xor_b32 v2, v2, v3
  v_lshl_add_u32 v9, v2, 4, v9
  v_subrev_u32 v9, 2048, v9
  v_lshrrev_b32 v2, 3, v1
  v_add_u32 v2, 24, v2
  v_mul_u32_u24 v10, 1280, v2
  v_bfe_u32 v2, v2, 1, 3
  v_and_b32 v3, 7, v1
  v_xor_b32 v2, v2, v3
  v_lshl_add_u32 v10, v2, 4, v10
  v_subrev_u32 v10, 3072, v10
  s_lshl_b32 s58, s46, 7
  s_lshl_b32 s61, s56, 5
  s_add_u32 s58, s58, s61
  s_mul_i32 s58, s58, 1280
  s_add_u32 s74, s58, 1280
  s_lshl_b32 s61, s51, 7
  s_add_u32 s58, s58, s61
  s_lshl_b32 s60, s56, 12
  s_add_u32 s60, s60, 49152
  s_waitcnt lgkmcnt(0)
  s_mov_b32 s32, s30
  s_and_b32 s33, s31, 0xffff
  s_mov_b32 s34, 0x1000000
  s_mov_b32 s35, 0x20000
  s_mov_b32 s36, s4
  s_and_b32 s37, s5, 0xffff
  s_mov_b32 s38, 0x280000
  s_mov_b32 s39, 0x20000
  s_cmp_lt_u32 s56, 2
  s_cselect_b32 s52, s20, s22
  s_cselect_b32 s53, s21, s23
  s_and_b32 s53, s53, 0xffff
  s_mov_b32 s54, 1966080
  s_mov_b32 s55, 0x20000
  s_add_u32 m0, s59, 0
  s_nop 0
  buffer_load_dwordx4 v4, s[52:55], s57 offen offset:0 lds
  buffer_load_dwordx4 v5, s[52:55], s57 offen offset:1024 lds
  buffer_load_dwordx4 v6, s[52:55], s57 offen offset:2048 lds
  s_add_u32 s57, s57, 98304
  s_cmp_ge_u32 s57, s75
  s_cselect_b32 s63, 1966080, 0
  s_sub_u32 s57, s57, s63
  s_add_u32 m0, s60, 0
  s_nop 0
  buffer_load_dwordx4 v7, s[36:39], s58 offen offset:0 lds
  buffer_load_dwordx4 v8, s[36:39], s58 offen offset:1024 lds
  buffer_load_dwordx4 v9, s[36:39], s58 offen offset:2048 lds
  buffer_load_dwordx4 v10, s[36:39], s58 offen offset:3072 lds
  s_add_u32 s58, s58, 128
  s_cmp_ge_u32 s58, s74
  s_cselect_b32 s63, 1280, 0
  s_sub_u32 s58, s58, s63
  s_add_u32 m0, s59, 12288
  s_nop 0
  buffer_load_dwordx4 v4, s[52:55], s57 offen offset:0 lds
  buffer_load_dwordx4 v5, s[52:55], s57 offen offset:1024 lds
  buffer_load_dwordx4 v6, s[52:55], s57 offen offset:2048 lds
  s_add_u32 s57, s57, 98304
  s_cmp_ge_u32 s57, s75
  s_cselect_b32 s63, 1966080, 0
  s_sub_u32 s57, s57, s63
  s_add_u32 m0, s59, 24576
  s_nop 0
  buffer_load_dwordx4 v4, s[52:55], s57 offen offset:0 lds
  buffer_load_dwordx4 v5, s[52:55], s57 offen offset:1024 lds
  buffer_load_dwordx4 v6, s[52:55], s57 offen offset:2048 lds
  s_add_u32 s57, s57, 98304
  s_cmp_ge_u32 s57, s75
  s_cselect_b32 s63, 1966080, 0
  s_sub_u32 s57, s57, s63
  s_add_u32 m0, s60, 16384
  s_nop 0
  buffer_load_dwordx4 v7, s[36:39], s58 offen offset:0 lds
  buffer_load_dwordx4 v8, s[36:39], s58 offen offset:1024 lds
  buffer_load_dwordx4 v9, s[36:39], s58 offen offset:2048 lds
  buffer_load_dwordx4 v10, s[36:39], s58 offen offset:3072 lds
  s_add_u32 s58, s58, 128
  s_cmp_ge_u32 s58, s74
  s_cselect_b32 s63, 1280, 0
  s_sub_u32 s58, s58, s63
  v_mov_b32 v254, 14286848
  buffer_load_dword v254, v254, s[32:35], 0 offen sc1
  v_lshrrev_b32 v2, 5, v1
  v_lshlrev_b32 v2, 3, v2
  v_bfe_u32 v3, v1, 2, 2
  v_add_u32 v2, v2, v3
  v_mul_u32_u24 v11, 192, v2
  v_and_b32 v3, 3, v1
  v_lshl_add_u32 v11, v3, 3, v11
  v_bfe_u32 v3, v1, 4, 1
  v_mul_u32_u24 v2, 6176, v3
  v_add_u32 v11, v11, v2
  s_lshr_b32 s61, s56, 1
  s_mul_i32 s63, s61, 96
  v_add_u32 v11, s63, v11
  s_mul_i32 s63, s61, 192
  v_mul_u32_u24 v2, s63, v3
  v_sub_u32 v12, v11, v2
  v_and_b32 v2, 31, v1
  s_and_b32 s61, s56, 1
  s_lshl_b32 s61, s61, 6
  v_add_u32 v2, s61, v2
  v_bfe_u32 v3, v2, 1, 3
  v_lshrrev_b32 v16, 5, v1
  v_xor_b32 v3, v3, v16
  v_lshlrev_b32 v2, 7, v2
  v_add_u32 v2, 49152, v2
  v_xor_b32 v13, 0, v3
  v_lshl_add_u32 v13, v13, 4, v2
  v_xor_b32 v14, 2, v3
  v_lshl_add_u32 v14, v14, 4, v2
  v_xor_b32 v15, 4, v3
  v_lshl_add_u32 v15, v15, 4, v2
  v_xor_b32 v16, 6, v3
  v_lshl_add_u32 v16, v16, 4, v2
  v_bfe_u32 v2, v1, 4, 1
  v_mul_u32_u24 v17, 49152, v2
  v_lshrrev_b32 v2, 5, v1
  v_lshl_add_u32 v17, v2, 8, v17
  v_and_b32 v2, 15, v1
  v_lshl_add_u32 v17, v2, 4, v17
  s_lshl_b32 s61, s46, 3
  s_and_b32 s63, s56, 1
  s_lshl_b32 s63, s63, 2
  s_add_u32 s61, s61, s63
  s_mul_i32 s61, s61, 49152
  s_mul_i32 s63, s47, 3072
  s_add_u32 s61, s61, s63
  s_lshr_b32 s63, s56, 1
  s_mul_i32 s63, s63, 1536
  s_add_u32 s61, s61, s63
  s_add_u32 s61, s61, 3145728
  v_add_u32 v17, s61, v17
  v_min_u32 v2, 23, v1
  s_mul_i32 s61, s56, 24
  v_add_u32 v2, s61, v2
  v_lshlrev_b32 v2, 6, v2
  v_add_u32 v19, 14712832, v2
  v_mov_b32 v216, 0
  v_mov_b32 v217, 0
  v_mov_b32 v218, 0
  v_mov_b32 v219, 0
  v_mov_b32 v220, 0
  v_mov_b32 v221, 0
  v_mov_b32 v222, 0
  v_mov_b32 v223, 0
  v_mov_b32 v224, 0
  v_mov_b32 v225, 0
  v_mov_b32 v226, 0
  v_mov_b32 v227, 0
  v_and_b32 v2, 15, v1
  v_bfe_u32 v3, v1, 4, 1
  v_cmp_eq_u32 vcc, v2, v3
  v_mov_b32 v2, 0x3f803f80
  s_nop 0
  v_cndmask_b32 v228, 0, v2, vcc
  v_cndmask_b32 v229, 0, v2, vcc
  v_cndmask_b32 v230, 0, v2, vcc
  v_cndmask_b32 v231, 0, v2, vcc
  s_and_b32 s61, s56, 1
  s_cmp_eq_u32 s61, 1
  s_cselect_b64 vcc, -1, 0
  s_setprio 1
  s_waitcnt vmcnt(11) lgkmcnt(0)
  s_barrier
  ds_read_b128 v[172:175], v13 offset:0
  ds_read_b64_tr_b16 v[160:161], v11 offset:0
  s_add_u32 m0, s59, 36864
  s_nop 0
  buffer_load_dwordx4 v4, s[52:55], s57 offen offset:0 lds
  ds_read_b64_tr_b16 v[162:163], v11 offset:768
  ds_read_b64_tr_b16 v[164:165], v11 offset:32
  ds_read_b64_tr_b16 v[166:167], v11 offset:800
  ds_read_b64_tr_b16 v[168:169], v12 offset:64
  buffer_load_dwordx4 v5, s[52:55], s57 offen offset:1024 lds
  ds_read_b64_tr_b16 v[170:171], v12 offset:832
  ds_read_b128 v[176:179], v13 offset:4096
  buffer_load_dwordx4 v6, s[52:55], s57 offen offset:2048 lds
  s_add_u32 s57, s57, 98304
  s_cmp_ge_u32 s57, s75
  s_cselect_b32 s63, 1966080, 0
  s_sub_u32 s57, s57, s63
  s_waitcnt lgkmcnt(5)
  v_mfma_f32_32x32x16_bf16 v[64:79], v[160:163], v[172:175], 0
  ds_read_b128 v[192:195], v14 offset:0
  ds_read_b64_tr_b16 v[180:181], v11 offset:3072
  s_waitcnt lgkmcnt(5)
  v_mfma_f32_32x32x16_bf16 v[96:111], v[164:167], v[172:175], 0
  ds_read_b64_tr_b16 v[182:183], v11 offset:3840
  ds_read_b64_tr_b16 v[184:185], v11 offset:3104
  s_waitcnt lgkmcnt(5)
  v_mfma_f32_32x32x16_bf16 v[128:143], v[168:171], v[172:175], 0
  ds_read_b64_tr_b16 v[186:187], v11 offset:3872
  ds_read_b64_tr_b16 v[188:189], v12 offset:3136
  s_waitcnt lgkmcnt(6)
  v_mfma_f32_32x32x16_bf16 v[80:95], v[160:163], v[176:179], 0
  s_cbranch_vccnz Lcs_2
  v_mfma_f32_16x16x32_bf16 v[216:219], v[160:163], v[228:231], v[216:219]
  v_mfma_f32_16x16x32_bf16 v[220:223], v[164:167], v[228:231], v[220:223]
  v_mfma_f32_16x16x32_bf16 v[224:227], v[168:171], v[228:231], v[224:227]
Lcs_2:
  ds_read_b64_tr_b16 v[190:191], v12 offset:3904
  ds_read_b128 v[196:199], v14 offset:4096
  v_mfma_f32_32x32x16_bf16 v[112:127], v[164:167], v[176:179], 0
  v_mfma_f32_32x32x16_bf16 v[144:159], v[168:171], v[176:179], 0
  s_waitcnt vmcnt(11) lgkmcnt(0)
  s_barrier
  v_mfma_f32_32x32x16_bf16 v[64:79], v[180:183], v[192:195], v[64:79]
  ds_read_b128 v[172:175], v15 offset:0
  ds_read_b64_tr_b16 v[160:161], v11 offset:12288
  s_add_u32 m0, s59, 0
  s_nop 0
  buffer_load_dwordx4 v4, s[52:55], s57 offen offset:0 lds
  v_mfma_f32_32x32x16_bf16 v[96:111], v[184:187], v[192:195], v[96:111]
  ds_read_b64_tr_b16 v[162:163], v11 offset:13056
  ds_read_b64_tr_b16 v[164:165], v11 offset:12320
  v_mfma_f32_32x32x16_bf16 v[128:143], v[188:191], v[192:195], v[128:143]
  ds_read_b64_tr_b16 v[166:167], v11 offset:13088
  ds_read_b64_tr_b16 v[168:169], v12 offset:12352
  buffer_load_dwordx4 v5, s[52:55], s57 offen offset:1024 lds
  v_mfma_f32_32x32x16_bf16 v[80:95], v[180:183], v[196:199], v[80:95]
  s_cbranch_vccz Lcs_3
  v_mfma_f32_16x16x32_bf16 v[216:219], v[180:183], v[228:231], v[216:219]
  v_mfma_f32_16x16x32_bf16 v[220:223], v[184:187], v[228:231], v[220:223]
  v_mfma_f32_16x16x32_bf16 v[224:227], v[188:191], v[228:231], v[224:227]
Lcs_3:
  ds_read_b64_tr_b16 v[170:171], v12 offset:13120
  ds_read_b128 v[176:179], v15 offset:4096
  v_mfma_f32_32x32x16_bf16 v[112:127], v[184:187], v[196:199], v[112:127]
  buffer_load_dwordx4 v6, s[52:55], s57 offen offset:2048 lds
  s_add_u32 s57, s57, 98304
  s_cmp_ge_u32 s57, s75
  s_cselect_b32 s63, 1966080, 0
  s_sub_u32 s57, s57, s63
  v_mfma_f32_32x32x16_bf16 v[144:159], v[188:191], v[196:199], v[144:159]
  s_waitcnt lgkmcnt(5)
  v_mfma_f32_32x32x16_bf16 v[64:79], v[160:163], v[172:175], v[64:79]
  ds_read_b128 v[192:195], v16 offset:0
  ds_read_b64_tr_b16 v[180:181], v11 offset:15360
  s_waitcnt lgkmcnt(5)
  v_mfma_f32_32x32x16_bf16 v[96:111], v[164:167], v[172:175], v[96:111]
  ds_read_b64_tr_b16 v[182:183], v11 offset:16128
  ds_read_b64_tr_b16 v[184:185], v11 offset:15392
  s_waitcnt lgkmcnt(5)
  v_mfma_f32_32x32x16_bf16 v[128:143], v[168:171], v[172:175], v[128:143]
  ds_read_b64_tr_b16 v[186:187], v11 offset:16160
  ds_read_b64_tr_b16 v[188:189], v12 offset:15424
  s_waitcnt lgkmcnt(6)
  v_mfma_f32_32x32x16_bf16 v[80:95], v[160:163], v[176:179], v[80:95]
  s_cbranch_vccnz Lcs_4
  v_mfma_f32_16x16x32_bf16 v[216:219], v[160:163], v[228:231], v[216:219]
  v_mfma_f32_16x16x32_bf16 v[220:223], v[164:167], v[228:231], v[220:223]
  v_mfma_f32_16x16x32_bf16 v[224:227], v[168:171], v[228:231], v[224:227]
Lcs_4:
  ds_read_b64_tr_b16 v[190:191], v12 offset:16192
  ds_read_b128 v[196:199], v16 offset:4096
  v_mfma_f32_32x32x16_bf16 v[112:127], v[164:167], v[176:179], v[112:127]
  v_mfma_f32_32x32x16_bf16 v[144:159], v[168:171], v[176:179], v[144:159]
  s_waitcnt vmcnt(7) lgkmcnt(0)
  s_barrier
  v_mfma_f32_32x32x16_bf16 v[64:79], v[180:183], v[192:195], v[64:79]
  ds_read_b128 v[172:175], v13 offset:16384
  ds_read_b64_tr_b16 v[160:161], v11 offset:24576
  s_add_u32 m0, s59, 12288
  s_nop 0
  buffer_load_dwordx4 v4, s[52:55], s57 offen offset:0 lds
  v_mfma_f32_32x32x16_bf16 v[96:111], v[184:187], v[192:195], v[96:111]
  ds_read_b64_tr_b16 v[162:163], v11 offset:25344
  ds_read_b64_tr_b16 v[164:165], v11 offset:24608
  v_mfma_f32_32x32x16_bf16 v[128:143], v[188:191], v[192:195], v[128:143]
  ds_read_b64_tr_b16 v[166:167], v11 offset:25376
  ds_read_b64_tr_b16 v[168:169], v12 offset:24640
  buffer_load_dwordx4 v5, s[52:55], s57 offen offset:1024 lds
  v_mfma_f32_32x32x16_bf16 v[80:95], v[180:183], v[196:199], v[80:95]
  s_cbranch_vccz Lcs_5
  v_mfma_f32_16x16x32_bf16 v[216:219], v[180:183], v[228:231], v[216:219]
  v_mfma_f32_16x16x32_bf16 v[220:223], v[184:187], v[228:231], v[220:223]
  v_mfma_f32_16x16x32_bf16 v[224:227], v[188:191], v[228:231], v[224:227]
Lcs_5:
  ds_read_b64_tr_b16 v[170:171], v12 offset:25408
  ds_read_b128 v[176:179], v13 offset:20480
  v_mfma_f32_32x32x16_bf16 v[112:127], v[184:187], v[196:199], v[112:127]
  buffer_load_dwordx4 v6, s[52:55], s57 offen offset:2048 lds
  s_add_u32 s57, s57, 98304
  s_cmp_ge_u32 s57, s75
  s_cselect_b32 s63, 1966080, 0
  s_sub_u32 s57, s57, s63
  v_mfma_f32_32x32x16_bf16 v[144:159], v[188:191], v[196:199], v[144:159]
  s_waitcnt lgkmcnt(5)
  v_mfma_f32_32x32x16_bf16 v[64:79], v[160:163], v[172:175], v[64:79]
  ds_read_b128 v[192:195], v14 offset:16384
  ds_read_b64_tr_b16 v[180:181], v11 offset:27648
  s_add_u32 m0, s60, 0
  s_nop 0
  buffer_load_dwordx4 v7, s[36:39], s58 offen offset:0 lds
  s_waitcnt lgkmcnt(5)
  v_mfma_f32_32x32x16_bf16 v[96:111], v[164:167], v[172:175], v[96:111]
  ds_read_b64_tr_b16 v[182:183], v11 offset:28416
  ds_read_b64_tr_b16 v[184:185], v11 offset:27680
  s_waitcnt lgkmcnt(5)
  v_mfma_f32_32x32x16_bf16 v[128:143], v[168:171], v[172:175], v[128:143]
  ds_read_b64_tr_b16 v[186:187], v11 offset:28448
  ds_read_b64_tr_b16 v[188:189], v12 offset:27712
  buffer_load_dwordx4 v8, s[36:39], s58 offen offset:1024 lds
  s_waitcnt lgkmcnt(6)
  v_mfma_f32_32x32x16_bf16 v[80:95], v[160:163], v[176:179], v[80:95]
  s_cbranch_vccnz Lcs_6
  v_mfma_f32_16x16x32_bf16 v[216:219], v[160:163], v[228:231], v[216:219]
  v_mfma_f32_16x16x32_bf16 v[220:223], v[164:167], v[228:231], v[220:223]
  v_mfma_f32_16x16x32_bf16 v[224:227], v[168:171], v[228:231], v[224:227]
Lcs_6:
  ds_read_b64_tr_b16 v[190:191], v12 offset:28480
  ds_read_b128 v[196:199], v14 offset:20480
  v_mfma_f32_32x32x16_bf16 v[112:127], v[164:167], v[176:179], v[112:127]
  buffer_load_dwordx4 v9, s[36:39], s58 offen offset:2048 lds
  v_mfma_f32_32x32x16_bf16 v[144:159], v[168:171], v[176:179], v[144:159]
  buffer_load_dwordx4 v10, s[36:39], s58 offen offset:3072 lds
  s_add_u32 s58, s58, 128
  s_cmp_ge_u32 s58, s74
  s_cselect_b32 s63, 1280, 0
  s_sub_u32 s58, s58, s63
  s_waitcnt vmcnt(10) lgkmcnt(0)
  s_barrier
  v_readfirstlane_b32 s40, v254
  s_nop 3
  s_add_u32 s40, s40, 0x9e3779b1
  v_mfma_f32_32x32x16_bf16 v[64:79], v[180:183], v[192:195], v[64:79]
  ds_read_b128 v[172:175], v15 offset:16384
  ds_read_b64_tr_b16 v[160:161], v11 offset:36864
  s_add_u32 m0, s59, 24576
  s_nop 0
  buffer_load_dwordx4 v4, s[52:55], s57 offen offset:0 lds
  v_mfma_f32_32x32x16_bf16 v[96:111], v[184:187], v[192:195], v[96:111]
  ds_read_b64_tr_b16 v[162:163], v11 offset:37632
  ds_read_b64_tr_b16 v[164:165], v11 offset:36896
  v_mfma_f32_32x32x16_bf16 v[128:143], v[188:191], v[192:195], v[128:143]
  ds_read_b64_tr_b16 v[166:167], v11 offset:37664
  ds_read_b64_tr_b16 v[168:169], v12 offset:36928
  buffer_load_dwordx4 v5, s[52:55], s57 offen offset:1024 lds
  v_mfma_f32_32x32x16_bf16 v[80:95], v[180:183], v[196:199], v[80:95]
  s_cbranch_vccz Lcs_7
  v_mfma_f32_16x16x32_bf16 v[216:219], v[180:183], v[228:231], v[216:219]
  v_mfma_f32_16x16x32_bf16 v[220:223], v[184:187], v[228:231], v[220:223]
  v_mfma_f32_16x16x32_bf16 v[224:227], v[188:191], v[228:231], v[224:227]
Lcs_7:
  ds_read_b64_tr_b16 v[170:171], v12 offset:37696
  ds_read_b128 v[176:179], v15 offset:20480
  v_mfma_f32_32x32x16_bf16 v[112:127], v[184:187], v[196:199], v[112:127]
  buffer_load_dwordx4 v6, s[52:55], s57 offen offset:2048 lds
  s_add_u32 s57, s57, 98304
  s_cmp_ge_u32 s57, s75
  s_cselect_b32 s63, 1966080, 0
  s_sub_u32 s57, s57, s63
  v_mfma_f32_32x32x16_bf16 v[144:159], v[188:191], v[196:199], v[144:159]
  s_waitcnt lgkmcnt(5)
  v_mfma_f32_32x32x16_bf16 v[64:79], v[160:163], v[172:175], v[64:79]
  ds_read_b128 v[192:195], v16 offset:16384
  ds_read_b64_tr_b16 v[180:181], v11 offset:39936
  s_waitcnt lgkmcnt(5)
  v_mfma_f32_32x32x16_bf16 v[96:111], v[164:167], v[172:175], v[96:111]
  ds_read_b64_tr_b16 v[182:183], v11 offset:40704
  ds_read_b64_tr_b16 v[184:185], v11 offset:39968
  s_waitcnt lgkmcnt(5)
  v_mfma_f32_32x32x16_bf16 v[128:143], v[168:171], v[172:175], v[128:143]
  ds_read_b64_tr_b16 v[186:187], v11 offset:40736
  ds_read_b64_tr_b16 v[188:189], v12 offset:40000
  s_waitcnt lgkmcnt(6)
  v_mfma_f32_32x32x16_bf16 v[80:95], v[160:163], v[176:179], v[80:95]
  s_cbranch_vccnz Lcs_8
  v_mfma_f32_16x16x32_bf16 v[216:219], v[160:163], v[228:231], v[216:219]
  v_mfma_f32_16x16x32_bf16 v[220:223], v[164:167], v[228:231], v[220:223]
  v_mfma_f32_16x16x32_bf16 v[224:227], v[168:171], v[228:231], v[224:227]
Lcs_8:
  ds_read_b64_tr_b16 v[190:191], v12 offset:40768
  ds_read_b128 v[196:199], v16 offset:20480
  v_mfma_f32_32x32x16_bf16 v[112:127], v[164:167], v[176:179], v[112:127]
  v_mfma_f32_32x32x16_bf16 v[144:159], v[168:171], v[176:179], v[144:159]
  s_mov_b32 s62, 2
Lup_9:
  s_waitcnt vmcnt(3) lgkmcnt(0)
  s_barrier
  v_mfma_f32_32x32x16_bf16 v[64:79], v[180:183], v[192:195], v[64:79]
  ds_read_b128 v[172:175], v13 offset:0
  ds_read_b64_tr_b16 v[160:161], v11 offset:0
  s_add_u32 m0, s59, 36864
  s_nop 0
  buffer_load_dwordx4 v4, s[52:55], s57 offen offset:0 lds
  v_mfma_f32_32x32x16_bf16 v[96:111], v[184:187], v[192:195], v[96:111]
  ds_read_b64_tr_b16 v[162:163], v11 offset:768
  ds_read_b64_tr_b16 v[164:165], v11 offset:32
  v_mfma_f32_32x32x16_bf16 v[128:143], v[188:191], v[192:195], v[128:143]
  ds_read_b64_tr_b16 v[166:167], v11 offset:800
  ds_read_b64_tr_b16 v[168:169], v12 offset:64
  buffer_load_dwordx4 v5, s[52:55], s57 offen offset:1024 lds
  v_mfma_f32_32x32x16_bf16 v[80:95], v[180:183], v[196:199], v[80:95]
  s_cbranch_vccz Lcs_10
  v_mfma_f32_16x16x32_bf16 v[216:219], v[180:183], v[228:231], v[216:219]
  v_mfma_f32_16x16x32_bf16 v[220:223], v[184:187], v[228:231], v[220:223]
  v_mfma_f32_16x16x32_bf16 v[224:227], v[188:191], v[228:231], v[224:227]
Lcs_10:
  ds_read_b64_tr_b16 v[170:171], v12 offset:832
  ds_read_b128 v[176:179], v13 offset:4096
  v_mfma_f32_32x32x16_bf16 v[112:127], v[184:187], v[196:199], v[112:127]
  buffer_load_dwordx4 v6, s[52:55], s57 offen offset:2048 lds
  s_add_u32 s57, s57, 98304
  s_cmp_ge_u32 s57, s75
  s_cselect_b32 s63, 1966080, 0
  s_sub_u32 s57, s57, s63
  v_mfma_f32_32x32x16_bf16 v[144:159], v[188:191], v[196:199], v[144:159]
  s_waitcnt lgkmcnt(5)
  v_mfma_f32_32x32x16_bf16 v[64:79], v[160:163], v[172:175], v[64:79]
  ds_read_b128 v[192:195], v14 offset:0
  ds_read_b64_tr_b16 v[180:181], v11 offset:3072
  s_add_u32 m0, s60, 16384
  s_nop 0
  buffer_load_dwordx4 v7, s[36:39], s58 offen offset:0 lds
  s_waitcnt lgkmcnt(5)
  v_mfma_f32_32x32x16_bf16 v[96:111], v[164:167], v[172:175], v[96:111]
  ds_read_b64_tr_b16 v[182:183], v11 offset:3840
  ds_read_b64_tr_b16 v[184:185], v11 offset:3104
  s_waitcnt lgkmcnt(5)
  v_mfma_f32_32x32x16_bf16 v[128:143], v[168:171], v[172:175], v[128:143]
  ds_read_b64_tr_b16 v[186:187], v11 offset:3872
  ds_read_b64_tr_b16 v[188:189], v12 offset:3136
  buffer_load_dwordx4 v8, s[36:39], s58 offen offset:1024 lds
  s_waitcnt lgkmcnt(6)
  v_mfma_f32_32x32x16_bf16 v[80:95], v[160:163], v[176:179], v[80:95]
  s_cbranch_vccnz Lcs_11
  v_mfma_f32_16x16x32_bf16 v[216:219], v[160:163], v[228:231], v[216:219]
  v_mfma_f32_16x16x32_bf16 v[220:223], v[164:167], v[228:231], v[220:223]
  v_mfma_f32_16x16x32_bf16 v[224:227], v[168:171], v[228:231], v[224:227]
Lcs_11:
  ds_read_b64_tr_b16 v[190:191], v12 offset:3904
  ds_read_b128 v[196:199], v14 offset:4096
  v_mfma_f32_32x32x16_bf16 v[112:127], v[164:167], v[176:179], v[112:127]
  buffer_load_dwordx4 v9, s[36:39], s58 offen offset:2048 lds
  v_mfma_f32_32x32x16_bf16 v[144:159], v[168:171], v[176:179], v[144:159]
  buffer_load_dwordx4 v10, s[36:39], s58 offen offset:3072 lds
  s_add_u32 s58, s58, 128
  s_cmp_ge_u32 s58, s74
  s_cselect_b32 s63, 1280, 0
  s_sub_u32 s58, s58, s63
  s_waitcnt vmcnt(10) lgkmcnt(0)
  s_barrier
  v_mfma_f32_32x32x16_bf16 v[64:79], v[180:183], v[192:195], v[64:79]
  ds_read_b128 v[172:175], v15 offset:0
  ds_read_b64_tr_b16 v[160:161], v11 offset:12288
  s_add_u32 m0, s59, 0
  s_nop 0
  buffer_load_dwordx4 v4, s[52:55], s57 offen offset:0 lds
  v_mfma_f32_32x32x16_bf16 v[96:111], v[184:187], v[192:195], v[96:111]
  ds_read_b64_tr_b16 v[162:163], v11 offset:13056
  ds_read_b64_tr_b16 v[164:165], v11 offset:12320
  v_mfma_f32_32x32x16_bf16 v[128:143], v[188:191], v[192:195], v[128:143]
  ds_read_b64_tr_b16 v[166:167], v11 offset:13088
  ds_read_b64_tr_b16 v[168:169], v12 offset:12352
  buffer_load_dwordx4 v5, s[52:55], s57 offen offset:1024 lds
  v_mfma_f32_32x32x16_bf16 v[80:95], v[180:183], v[196:199], v[80:95]
  s_cbranch_vccz Lcs_12
  v_mfma_f32_16x16x32_bf16 v[216:219], v[180:183], v[228:231], v[216:219]
  v_mfma_f32_16x16x32_bf16 v[220:223], v[184:187], v[228:231], v[220:223]
  v_mfma_f32_16x16x32_bf16 v[224:227], v[188:191], v[228:231], v[224:227]
Lcs_12:
  ds_read_b64_tr_b16 v[170:171], v12 offset:13120
  ds_read_b128 v[176:179], v15 offset:4096
  v_mfma_f32_32x32x16_bf16 v[112:127], v[184:187], v[196:199], v[112:127]
  buffer_load_dwordx4 v6, s[52:55], s57 offen offset:2048 lds
  s_add_u32 s57, s57, 98304
  s_cmp_ge_u32 s57, s75
  s_cselect_b32 s63, 1966080, 0
  s_sub_u32 s57, s57, s63
  v_mfma_f32_32x32x16_bf16 v[144:159], v[188:191], v[196:199], v[144:159]
  s_waitcnt lgkmcnt(5)
  v_mfma_f32_32x32x16_bf16 v[64:79], v[160:163], v[172:175], v[64:79]
  ds_read_b128 v[192:195], v16 offset:0
  ds_read_b64_tr_b16 v[180:181], v11 offset:15360
  s_waitcnt lgkmcnt(5)
  v_mfma_f32_32x32x16_bf16 v[96:111], v[164:167], v[172:175], v[96:111]
  ds_read_b64_tr_b16 v[182:183], v11 offset:16128
  ds_read_b64_tr_b16 v[184:185], v11 offset:15392
  s_waitcnt lgkmcnt(5)
  v_mfma_f32_32x32x16_bf16 v[128:143], v[168:171], v[172:175], v[128:143]
  ds_read_b64_tr_b16 v[186:187], v11 offset:16160
  ds_read_b64_tr_b16 v[188:189], v12 offset:15424
  s_waitcnt lgkmcnt(6)
  v_mfma_f32_32x32x16_bf16 v[80:95], v[160:163], v[176:179], v[80:95]
  s_cbranch_vccnz Lcs_13
  v_mfma_f32_16x16x32_bf16 v[216:219], v[160:163], v[228:231], v[216:219]
  v_mfma_f32_16x16x32_bf16 v[220:223], v[164:167], v[228:231], v[220:223]
  v_mfma_f32_16x16x32_bf16 v[224:227], v[168:171], v[228:231], v[224:227]
Lcs_13:
  ds_read_b64_tr_b16 v[190:191], v12 offset:16192
  ds_read_b128 v[196:199], v16 offset:4096
  v_mfma_f32_32x32x16_bf16 v[112:127], v[164:167], v[176:179], v[112:127]
  v_mfma_f32_32x32x16_bf16 v[144:159], v[168:171], v[176:179], v[144:159]
  s_waitcnt vmcnt(3) lgkmcnt(0)
  s_barrier
  v_mfma_f32_32x32x16_bf16 v[64:79], v[180:183], v[192:195], v[64:79]
  ds_read_b128 v[172:175], v13 offset:16384
  ds_read_b64_tr_b16 v[160:161], v11 offset:24576
  s_add_u32 m0, s59, 12288
  s_nop 0
  buffer_load_dwordx4 v4, s[52:55], s57 offen offset:0 lds
  v_mfma_f32_32x32x16_bf16 v[96:111], v[184:187], v[192:195], v[96:111]
  ds_read_b64_tr_b16 v[162:163], v11 offset:25344
  ds_read_b64_tr_b16 v[164:165], v11 offset:24608
  v_mfma_f32_32x32x16_bf16 v[128:143], v[188:191], v[192:195], v[128:143]
  ds_read_b64_tr_b16 v[166:167], v11 offset:25376
  ds_read_b64_tr_b16 v[168:169], v12 offset:24640
  buffer_load_dwordx4 v5, s[52:55], s57 offen offset:1024 lds
  v_mfma_f32_32x32x16_bf16 v[80:95], v[180:183], v[196:199], v[80:95]
  s_cbranch_vccz Lcs_14
  v_mfma_f32_16x16x32_bf16 v[216:219], v[180:183], v[228:231], v[216:219]
  v_mfma_f32_16x16x32_bf16 v[220:223], v[184:187], v[228:231], v[220:223]
  v_mfma_f32_16x16x32_bf16 v[224:227], v[188:191], v[228:231], v[224:227]
Lcs_14:
  ds_read_b64_tr_b16 v[170:171], v12 offset:25408
  ds_read_b128 v[176:179], v13 offset:20480
  v_mfma_f32_32x32x16_bf16 v[112:127], v[184:187], v[196:199], v[112:127]
  buffer_load_dwordx4 v6, s[52:55], s57 offen offset:2048 lds
  s_add_u32 s57, s57, 98304
  s_cmp_ge_u32 s57, s75
  s_cselect_b32 s63, 1966080, 0
  s_sub_u32 s57, s57, s63
  v_mfma_f32_32x32x16_bf16 v[144:159], v[188:191], v[196:199], v[144:159]
  s_waitcnt lgkmcnt(5)
  v_mfma_f32_32x32x16_bf16 v[64:79], v[160:163], v[172:175], v[64:79]
  ds_read_b128 v[192:195], v14 offset:16384
  ds_read_b64_tr_b16 v[180:181], v11 offset:27648
  s_add_u32 m0, s60, 0
  s_nop 0
  buffer_load_dwordx4 v7, s[36:39], s58 offen offset:0 lds
  s_waitcnt lgkmcnt(5)
  v_mfma_f32_32x32x16_bf16 v[96:111], v[164:167], v[172:175], v[96:111]
  ds_read_b64_tr_b16 v[182:183], v11 offset:28416
  ds_read_b64_tr_b16 v[184:185], v11 offset:27680
  s_waitcnt lgkmcnt(5)
  v_mfma_f32_32x32x16_bf16 v[128:143], v[168:171], v[172:175], v[128:143]
  ds_read_b64_tr_b16 v[186:187], v11 offset:28448
  ds_read_b64_tr_b16 v[188:189], v12 offset:27712
  buffer_load_dwordx4 v8, s[36:39], s58 offen offset:1024 lds
  s_waitcnt lgkmcnt(6)
  v_mfma_f32_32x32x16_bf16 v[80:95], v[160:163], v[176:179], v[80:95]
  s_cbranch_vccnz Lcs_15
  v_mfma_f32_16x16x32_bf16 v[216:219], v[160:163], v[228:231], v[216:219]
  v_mfma_f32_16x16x32_bf16 v[220:223], v[164:167], v[228:231], v[220:223]
  v_mfma_f32_16x16x32_bf16 v[224:227], v[168:171], v[228:231], v[224:227]
Lcs_15:
  ds_read_b64_tr_b16 v[190:191], v12 offset:28480
  ds_read_b128 v[196:199], v14 offset:20480
  v_mfma_f32_32x32x16_bf16 v[112:127], v[164:167], v[176:179], v[112:127]
  buffer_load_dwordx4 v9, s[36:39], s58 offen offset:2048 lds
  v_mfma_f32_32x32x16_bf16 v[144:159], v[168:171], v[176:179], v[144:159]
  buffer_load_dwordx4 v10, s[36:39], s58 offen offset:3072 lds
  s_add_u32 s58, s58, 128
  s_cmp_ge_u32 s58, s74
  s_cselect_b32 s63, 1280, 0
  s_sub_u32 s58, s58, s63
  s_waitcnt vmcnt(10) lgkmcnt(0)
  s_barrier
  v_mfma_f32_32x32x16_bf16 v[64:79], v[180:183], v[192:195], v[64:79]
  ds_read_b128 v[172:175], v15 offset:16384
  ds_read_b64_tr_b16 v[160:161], v11 offset:36864
  s_add_u32 m0, s59, 24576
  s_nop 0
  buffer_load_dwordx4 v4, s[52:55], s57 offen offset:0 lds
  v_mfma_f32_32x32x16_bf16 v[96:111], v[184:187], v[192:195], v[96:111]
  ds_read_b64_tr_b16 v[162:163], v11 offset:37632
  ds_read_b64_tr_b16 v[164:165], v11 offset:36896
  v_mfma_f32_32x32x16_bf16 v[128:143], v[188:191], v[192:195], v[128:143]
  ds_read_b64_tr_b16 v[166:167], v11 offset:37664
  ds_read_b64_tr_b16 v[168:169], v12 offset:36928
  buffer_load_dwordx4 v5, s[52:55], s57 offen offset:1024 lds
  v_mfma_f32_32x32x16_bf16 v[80:95], v[180:183], v[196:199], v[80:95]
  s_cbranch_vccz Lcs_16
  v_mfma_f32_16x16x32_bf16 v[216:219], v[180:183], v[228:231], v[216:219]
  v_mfma_f32_16x16x32_bf16 v[220:223], v[184:187], v[228:231], v[220:223]
  v_mfma_f32_16x16x32_bf16 v[224:227], v[188:191], v[228:231], v[224:227]
Lcs_16:
  ds_read_b64_tr_b16 v[170:171], v12 offset:37696
  ds_read_b128 v[176:179], v15 offset:20480
  v_mfma_f32_32x32x16_bf16 v[112:127], v[184:187], v[196:199], v[112:127]
  buffer_load_dwordx4 v6, s[52:55], s57 offen offset:2048 lds
  s_add_u32 s57, s57, 98304
  s_cmp_ge_u32 s57, s75
  s_cselect_b32 s63, 1966080, 0
  s_sub_u32 s57, s57, s63
  v_mfma_f32_32x32x16_bf16 v[144:159], v[188:191], v[196:199], v[144:159]
  s_waitcnt lgkmcnt(5)
  v_mfma_f32_32x32x16_bf16 v[64:79], v[160:163], v[172:175], v[64:79]
  ds_read_b128 v[192:195], v16 offset:16384
  ds_read_b64_tr_b16 v[180:181], v11 offset:39936
  s_waitcnt lgkmcnt(5)
  v_mfma_f32_32x32x16_bf16 v[96:111], v[164:167], v[172:175], v[96:111]
  ds_read_b64_tr_b16 v[182:183], v11 offset:40704
  ds_read_b64_tr_b16 v[184:185], v11 offset:39968
  s_waitcnt lgkmcnt(5)
  v_mfma_f32_32x32x16_bf16 v[128:143], v[168:171], v[172:175], v[128:143]
  ds_read_b64_tr_b16 v[186:187], v11 offset:40736
  ds_read_b64_tr_b16 v[188:189], v12 offset:40000
  s_waitcnt lgkmcnt(6)
  v_mfma_f32_32x32x16_bf16 v[80:95], v[160:163], v[176:179], v[80:95]
  s_cbranch_vccnz Lcs_17
  v_mfma_f32_16x16x32_bf16 v[216:219], v[160:163], v[228:231], v[216:219]
  v_mfma_f32_16x16x32_bf16 v[220:223], v[164:167], v[228:231], v[220:223]
  v_mfma_f32_16x16x32_bf16 v[224:227], v[168:171], v[228:231], v[224:227]
Lcs_17:
  ds_read_b64_tr_b16 v[190:191], v12 offset:40768
  ds_read_b128 v[196:199], v16 offset:20480
  v_mfma_f32_32x32x16_bf16 v[112:127], v[164:167], v[176:179], v[112:127]
  v_mfma_f32_32x32x16_bf16 v[144:159], v[168:171], v[176:179], v[144:159]
  s_sub_u32 s62, s62, 1
  s_cmp_lg_u32 s62, 0
  s_cbranch_scc1 Lup_9
  s_waitcnt vmcnt(3) lgkmcnt(0)
  s_barrier
  v_mfma_f32_32x32x16_bf16 v[64:79], v[180:183], v[192:195], v[64:79]
  ds_read_b128 v[172:175], v13 offset:0
  ds_read_b64_tr_b16 v[160:161], v11 offset:0
  s_add_u32 m0, s59, 36864
  s_nop 0
  buffer_load_dwordx4 v4, s[52:55], s57 offen offset:0 lds
  v_mfma_f32_32x32x16_bf16 v[96:111], v[184:187], v[192:195], v[96:111]
  ds_read_b64_tr_b16 v[162:163], v11 offset:768
  ds_read_b64_tr_b16 v[164:165], v11 offset:32
  v_mfma_f32_32x32x16_bf16 v[128:143], v[188:191], v[192:195], v[128:143]
  ds_read_b64_tr_b16 v[166:167], v11 offset:800
  ds_read_b64_tr_b16 v[168:169], v12 offset:64
  buffer_load_dwordx4 v5, s[52:55], s57 offen offset:1024 lds
  v_mfma_f32_32x32x16_bf16 v[80:95], v[180:183], v[196:199], v[80:95]
  s_cbranch_vccz Lcs_26
  v_mfma_f32_16x16x32_bf16 v[216:219], v[180:183], v[228:231], v[216:219]
  v_mfma_f32_16x16x32_bf16 v[220:223], v[184:187], v[228:231], v[220:223]
  v_mfma_f32_16x16x32_bf16 v[224:227], v[188:191], v[228:231], v[224:227]
Lcs_26:
  ds_read_b64_tr_b16 v[170:171], v12 offset:832
  ds_read_b128 v[176:179], v13 offset:4096
  v_mfma_f32_32x32x16_bf16 v[112:127], v[184:187], v[196:199], v[112:127]
  buffer_load_dwordx4 v6, s[52:55], s57 offen offset:2048 lds
  s_add_u32 s57, s57, 98304
  s_cmp_ge_u32 s57, s75
  s_cselect_b32 s63, 1966080, 0
  s_sub_u32 s57, s57, s63
  v_mfma_f32_32x32x16_bf16 v[144:159], v[188:191], v[196:199], v[144:159]
  s_waitcnt lgkmcnt(5)
  v_mfma_f32_32x32x16_bf16 v[64:79], v[160:163], v[172:175], v[64:79]
  ds_read_b128 v[192:195], v14 offset:0
  ds_read_b64_tr_b16 v[180:181], v11 offset:3072
  s_add_u32 m0, s60, 16384
  s_nop 0
  buffer_load_dwordx4 v7, s[36:39], s58 offen offset:0 lds
  s_waitcnt lgkmcnt(5)
  v_mfma_f32_32x32x16_bf16 v[96:111], v[164:167], v[172:175], v[96:111]
  ds_read_b64_tr_b16 v[182:183], v11 offset:3840
  ds_read_b64_tr_b16 v[184:185], v11 offset:3104
  s_waitcnt lgkmcnt(5)
  v_mfma_f32_32x32x16_bf16 v[128:143], v[168:171], v[172:175], v[128:143]
  ds_read_b64_tr_b16 v[186:187], v11 offset:3872
  ds_read_b64_tr_b16 v[188:189], v12 offset:3136
  buffer_load_dwordx4 v8, s[36:39], s58 offen offset:1024 lds
  s_waitcnt lgkmcnt(6)
  v_mfma_f32_32x32x16_bf16 v[80:95], v[160:163], v[176:179], v[80:95]
  s_cbranch_vccnz Lcs_27
  v_mfma_f32_16x16x32_bf16 v[216:219], v[160:163], v[228:231], v[216:219]
  v_mfma_f32_16x16x32_bf16 v[220:223], v[164:167], v[228:231], v[220:223]
  v_mfma_f32_16x16x32_bf16 v[224:227], v[168:171], v[228:231], v[224:227]
Lcs_27:
  ds_read_b64_tr_b16 v[190:191], v12 offset:3904
  ds_read_b128 v[196:199], v14 offset:4096
  v_mfma_f32_32x32x16_bf16 v[112:127], v[164:167], v[176:179], v[112:127]
  buffer_load_dwordx4 v9, s[36:39], s58 offen offset:2048 lds
  v_mfma_f32_32x32x16_bf16 v[144:159], v[168:171], v[176:179], v[144:159]
  buffer_load_dwordx4 v10, s[36:39], s58 offen offset:3072 lds
  s_add_u32 s58, s58, 128
  s_cmp_ge_u32 s58, s74
  s_cselect_b32 s63, 1280, 0
  s_sub_u32 s58, s58, s63
  s_waitcnt vmcnt(10) lgkmcnt(0)
  s_barrier
  v_mfma_f32_32x32x16_bf16 v[64:79], v[180:183], v[192:195], v[64:79]
  ds_read_b128 v[172:175], v15 offset:0
  ds_read_b64_tr_b16 v[160:161], v11 offset:12288
  s_add_u32 m0, s59, 0
  s_nop 0
  buffer_load_dwordx4 v4, s[52:55], s57 offen offset:0 lds
  v_mfma_f32_32x32x16_bf16 v[96:111], v[184:187], v[192:195], v[96:111]
  ds_read_b64_tr_b16 v[162:163], v11 offset:13056
  ds_read_b64_tr_b16 v[164:165], v11 offset:12320
  v_mfma_f32_32x32x16_bf16 v[128:143], v[188:191], v[192:195], v[128:143]
  ds_read_b64_tr_b16 v[166:167], v11 offset:13088
  ds_read_b64_tr_b16 v[168:169], v12 offset:12352
  buffer_load_dwordx4 v5, s[52:55], s57 offen offset:1024 lds
  v_mfma_f32_32x32x16_bf16 v[80:95], v[180:183], v[196:199], v[80:95]
  s_cbranch_vccz Lcs_28
  v_mfma_f32_16x16x32_bf16 v[216:219], v[180:183], v[228:231], v[216:219]
  v_mfma_f32_16x16x32_bf16 v[220:223], v[184:187], v[228:231], v[220:223]
  v_mfma_f32_16x16x32_bf16 v[224:227], v[188:191], v[228:231], v[224:227]
Lcs_28:
  ds_read_b64_tr_b16 v[170:171], v12 offset:13120
  ds_read_b128 v[176:179], v15 offset:4096
  v_mfma_f32_32x32x16_bf16 v[112:127], v[184:187], v[196:199], v[112:127]
  buffer_load_dwordx4 v6, s[52:55], s57 offen offset:2048 lds
  s_add_u32 s57, s57, 98304
  s_cmp_ge_u32 s57, s75
  s_cselect_b32 s63, 1966080, 0
  s_sub_u32 s57, s57, s63
  v_mfma_f32_32x32x16_bf16 v[144:159], v[188:191], v[196:199], v[144:159]
  s_waitcnt lgkmcnt(5)
  v_mfma_f32_32x32x16_bf16 v[64:79], v[160:163], v[172:175], v[64:79]
  ds_read_b128 v[192:195], v16 offset:0
  ds_read_b64_tr_b16 v[180:181], v11 offset:15360
  s_waitcnt lgkmcnt(5)
  v_mfma_f32_32x32x16_bf16 v[96:111], v[164:167], v[172:175], v[96:111]
  ds_read_b64_tr_b16 v[182:183], v11 offset:16128
  ds_read_b64_tr_b16 v[184:185], v11 offset:15392
  s_waitcnt lgkmcnt(5)
  v_mfma_f32_32x32x16_bf16 v[128:143], v[168:171], v[172:175], v[128:143]
  ds_read_b64_tr_b16 v[186:187], v11 offset:16160
  ds_read_b64_tr_b16 v[188:189], v12 offset:15424
  s_waitcnt lgkmcnt(6)
  v_mfma_f32_32x32x16_bf16 v[80:95], v[160:163], v[176:179], v[80:95]
  s_cbranch_vccnz Lcs_29
  v_mfma_f32_16x16x32_bf16 v[216:219], v[160:163], v[228:231], v[216:219]
  v_mfma_f32_16x16x32_bf16 v[220:223], v[164:167], v[228:231], v[220:223]
  v_mfma_f32_16x16x32_bf16 v[224:227], v[168:171], v[228:231], v[224:227]
Lcs_29:
  ds_read_b64_tr_b16 v[190:191], v12 offset:16192
  ds_read_b128 v[196:199], v16 offset:4096
  v_mfma_f32_32x32x16_bf16 v[112:127], v[164:167], v[176:179], v[112:127]
  v_mfma_f32_32x32x16_bf16 v[144:159], v[168:171], v[176:179], v[144:159]
  s_waitcnt vmcnt(3) lgkmcnt(0)
  s_barrier
  v_mfma_f32_32x32x16_bf16 v[64:79], v[180:183], v[192:195], v[64:79]
  ds_read_b128 v[172:175], v13 offset:16384
  ds_read_b64_tr_b16 v[160:161], v11 offset:24576
  s_add_u32 m0, s59, 12288
  s_nop 0
  buffer_load_dwordx4 v4, s[52:55], s57 offen offset:0 lds
  v_mfma_f32_32x32x16_bf16 v[96:111], v[184:187], v[192:195], v[96:111]
  ds_read_b64_tr_b16 v[162:163], v11 offset:25344
  ds_read_b64_tr_b16 v[164:165], v11 offset:24608
  v_mfma_f32_32x32x16_bf16 v[128:143], v[188:191], v[192:195], v[128:143]
  ds_read_b64_tr_b16 v[166:167], v11 offset:25376
  ds_read_b64_tr_b16 v[168:169], v12 offset:24640
  buffer_load_dwordx4 v5, s[52:55], s57 offen offset:1024 lds
  v_mfma_f32_32x32x16_bf16 v[80:95], v[180:183], v[196:199], v[80:95]
  s_cbranch_vccz Lcs_30
  v_mfma_f32_16x16x32_bf16 v[216:219], v[180:183], v[228:231], v[216:219]
  v_mfma_f32_16x16x32_bf16 v[220:223], v[184:187], v[228:231], v[220:223]
  v_mfma_f32_16x16x32_bf16 v[224:227], v[188:191], v[228:231], v[224:227]
Lcs_30:
  ds_read_b64_tr_b16 v[170:171], v12 offset:25408
  ds_read_b128 v[176:179], v13 offset:20480
  v_mfma_f32_32x32x16_bf16 v[112:127], v[184:187], v[196:199], v[112:127]
  buffer_load_dwordx4 v6, s[52:55], s57 offen offset:2048 lds
  s_add_u32 s57, s57, 98304
  s_cmp_ge_u32 s57, s75
  s_cselect_b32 s63, 1966080, 0
  s_sub_u32 s57, s57, s63
  v_mfma_f32_32x32x16_bf16 v[144:159], v[188:191], v[196:199], v[144:159]
  s_waitcnt lgkmcnt(5)
  v_mfma_f32_32x32x16_bf16 v[64:79], v[160:163], v[172:175], v[64:79]
  ds_read_b128 v[192:195], v14 offset:16384
  ds_read_b64_tr_b16 v[180:181], v11 offset:27648
  s_add_u32 m0, s60, 0
  s_nop 0
  buffer_load_dwordx4 v7, s[36:39], s58 offen offset:0 lds
  s_waitcnt lgkmcnt(5)
  v_mfma_f32_32x32x16_bf16 v[96:111], v[164:167], v[172:175], v[96:111]
  ds_read_b64_tr_b16 v[182:183], v11 offset:28416
  ds_read_b64_tr_b16 v[184:185], v11 offset:27680
  s_waitcnt lgkmcnt(5)
  v_mfma_f32_32x32x16_bf16 v[128:143], v[168:171], v[172:175], v[128:143]
  ds_read_b64_tr_b16 v[186:187], v11 offset:28448
  ds_read_b64_tr_b16 v[188:189], v12 offset:27712
  buffer_load_dwordx4 v8, s[36:39], s58 offen offset:1024 lds
  s_waitcnt lgkmcnt(6)
  v_mfma_f32_32x32x16_bf16 v[80:95], v[160:163], v[176:179], v[80:95]
  s_cbranch_vccnz Lcs_31
  v_mfma_f32_16x16x32_bf16 v[216:219], v[160:163], v[228:231], v[216:219]
  v_mfma_f32_16x16x32_bf16 v[220:223], v[164:167], v[228:231], v[220:223]
  v_mfma_f32_16x16x32_bf16 v[224:227], v[168:171], v[228:231], v[224:227]
Lcs_31:
  ds_read_b64_tr_b16 v[190:191], v12 offset:28480
  ds_read_b128 v[196:199], v14 offset:20480
  v_mfma_f32_32x32x16_bf16 v[112:127], v[164:167], v[176:179], v[112:127]
  buffer_load_dwordx4 v9, s[36:39], s58 offen offset:2048 lds
  v_mfma_f32_32x32x16_bf16 v[144:159], v[168:171], v[176:179], v[144:159]
  buffer_load_dwordx4 v10, s[36:39], s58 offen offset:3072 lds
  s_add_u32 s58, s58, 128
  s_cmp_ge_u32 s58, s74
  s_cselect_b32 s63, 1280, 0
  s_sub_u32 s58, s58, s63
  s_waitcnt vmcnt(10) lgkmcnt(0)
  s_barrier
  v_mfma_f32_32x32x16_bf16 v[64:79], v[180:183], v[192:195], v[64:79]
  ds_read_b128 v[172:175], v15 offset:16384
  ds_read_b64_tr_b16 v[160:161], v11 offset:36864
  s_add_u32 m0, s59, 24576
  s_nop 0
  buffer_load_dwordx4 v4, s[52:55], s57 offen offset:0 lds
  v_mfma_f32_32x32x16_bf16 v[96:111], v[184:187], v[192:195], v[96:111]
  ds_read_b64_tr_b16 v[162:163], v11 offset:37632
  ds_read_b64_tr_b16 v[164:165], v11 offset:36896
  v_mfma_f32_32x32x16_bf16 v[128:143], v[188:191], v[192:195], v[128:143]
  ds_read_b64_tr_b16 v[166:167], v11 offset:37664
  ds_read_b64_tr_b16 v[168:169], v12 offset:36928
  buffer_load_dwordx4 v5, s[52:55], s57 offen offset:1024 lds
  v_mfma_f32_32x32x16_bf16 v[80:95], v[180:183], v[196:199], v[80:95]
  s_cbranch_vccz Lcs_32
  v_mfma_f32_16x16x32_bf16 v[216:219], v[180:183], v[228:231], v[216:219]
  v_mfma_f32_16x16x32_bf16 v[220:223], v[184:187], v[228:231], v[220:223]
  v_mfma_f32_16x16x32_bf16 v[224:227], v[188:191], v[228:231], v[224:227]
Lcs_32:
  ds_read_b64_tr_b16 v[170:171], v12 offset:37696
  ds_read_b128 v[176:179], v15 offset:20480
  v_mfma_f32_32x32x16_bf16 v[112:127], v[184:187], v[196:199], v[112:127]
  buffer_load_dwordx4 v6, s[52:55], s57 offen offset:2048 lds
  s_add_u32 s57, s57, 98304
  s_cmp_ge_u32 s57, s75
  s_cselect_b32 s63, 1966080, 0
  s_sub_u32 s57, s57, s63
  v_mfma_f32_32x32x16_bf16 v[144:159], v[188:191], v[196:199], v[144:159]
  s_waitcnt lgkmcnt(5)
  v_mfma_f32_32x32x16_bf16 v[64:79], v[160:163], v[172:175], v[64:79]
  ds_read_b128 v[192:195], v16 offset:16384
  ds_read_b64_tr_b16 v[180:181], v11 offset:39936
  s_waitcnt lgkmcnt(5)
  v_mfma_f32_32x32x16_bf16 v[96:111], v[164:167], v[172:175], v[96:111]
  ds_read_b64_tr_b16 v[182:183], v11 offset:40704
  ds_read_b64_tr_b16 v[184:185], v11 offset:39968
  s_waitcnt lgkmcnt(5)
  v_mfma_f32_32x32x16_bf16 v[128:143], v[168:171], v[172:175], v[128:143]
  ds_read_b64_tr_b16 v[186:187], v11 offset:40736
  ds_read_b64_tr_b16 v[188:189], v12 offset:40000
  s_waitcnt lgkmcnt(6)
  v_mfma_f32_32x32x16_bf16 v[80:95], v[160:163], v[176:179], v[80:95]
  s_cbranch_vccnz Lcs_33
  v_mfma_f32_16x16x32_bf16 v[216:219], v[160:163], v[228:231], v[216:219]
  v_mfma_f32_16x16x32_bf16 v[220:223], v[164:167], v[228:231], v[220:223]
  v_mfma_f32_16x16x32_bf16 v[224:227], v[168:171], v[228:231], v[224:227]
Lcs_33:
  ds_read_b64_tr_b16 v[190:191], v12 offset:40768
  ds_read_b128 v[196:199], v16 offset:20480
  v_mfma_f32_32x32x16_bf16 v[112:127], v[164:167], v[176:179], v[112:127]
  v_mfma_f32_32x32x16_bf16 v[144:159], v[168:171], v[176:179], v[144:159]
  s_waitcnt vmcnt(3) lgkmcnt(0)
  s_barrier
  v_mfma_f32_32x32x16_bf16 v[64:79], v[180:183], v[192:195], v[64:79]
  ds_read_b128 v[172:175], v13 offset:0
  ds_read_b64_tr_b16 v[160:161], v11 offset:0
  s_add_u32 m0, s59, 36864
  s_nop 0
  buffer_load_dwordx4 v4, s[52:55], s57 offen offset:0 lds
  v_mfma_f32_32x32x16_bf16 v[96:111], v[184:187], v[192:195], v[96:111]
  ds_read_b64_tr_b16 v[162:163], v11 offset:768
  ds_read_b64_tr_b16 v[164:165], v11 offset:32
  v_mfma_f32_32x32x16_bf16 v[128:143], v[188:191], v[192:195], v[128:143]
  ds_read_b64_tr_b16 v[166:167], v11 offset:800
  ds_read_b64_tr_b16 v[168:169], v12 offset:64
  buffer_load_dwordx4 v5, s[52:55], s57 offen offset:1024 lds
  v_mfma_f32_32x32x16_bf16 v[80:95], v[180:183], v[196:199], v[80:95]
  s_cbranch_vccz Lcs_34
  v_mfma_f32_16x16x32_bf16 v[216:219], v[180:183], v[228:231], v[216:219]
  v_mfma_f32_16x16x32_bf16 v[220:223], v[184:187], v[228:231], v[220:223]
  v_mfma_f32_16x16x32_bf16 v[224:227], v[188:191], v[228:231], v[224:227]
Lcs_34:
  ds_read_b64_tr_b16 v[170:171], v12 offset:832
  ds_read_b128 v[176:179], v13 offset:4096
  v_mfma_f32_32x32x16_bf16 v[112:127], v[184:187], v[196:199], v[112:127]
  buffer_load_dwordx4 v6, s[52:55], s57 offen offset:2048 lds
  s_add_u32 s57, s57, 98304
  s_cmp_ge_u32 s57, s75
  s_cselect_b32 s63, 1966080, 0
  s_sub_u32 s57, s57, s63
  v_mfma_f32_32x32x16_bf16 v[144:159], v[188:191], v[196:199], v[144:159]
  s_waitcnt lgkmcnt(5)
  v_mfma_f32_32x32x16_bf16 v[64:79], v[160:163], v[172:175], v[64:79]
  ds_read_b128 v[192:195], v14 offset:0
  ds_read_b64_tr_b16 v[180:181], v11 offset:3072
  s_add_u32 m0, s60, 16384
  s_nop 0
  buffer_load_dwordx4 v7, s[36:39], s58 offen offset:0 lds
  s_waitcnt lgkmcnt(5)
  v_mfma_f32_32x32x16_bf16 v[96:111], v[164:167], v[172:175], v[96:111]
  ds_read_b64_tr_b16 v[182:183], v11 offset:3840
  ds_read_b64_tr_b16 v[184:185], v11 offset:3104
  s_waitcnt lgkmcnt(5)
  v_mfma_f32_32x32x16_bf16 v[128:143], v[168:171], v[172:175], v[128:143]
  ds_read_b64_tr_b16 v[186:187], v11 offset:3872
  ds_read_b64_tr_b16 v[188:189], v12 offset:3136
  buffer_load_dwordx4 v8, s[36:39], s58 offen offset:1024 lds
  s_waitcnt lgkmcnt(6)
  v_mfma_f32_32x32x16_bf16 v[80:95], v[160:163], v[176:179], v[80:95]
  s_cbranch_vccnz Lcs_35
  v_mfma_f32_16x16x32_bf16 v[216:219], v[160:163], v[228:231], v[216:219]
  v_mfma_f32_16x16x32_bf16 v[220:223], v[164:167], v[228:231], v[220:223]
  v_mfma_f32_16x16x32_bf16 v[224:227], v[168:171], v[228:231], v[224:227]
Lcs_35:
  ds_read_b64_tr_b16 v[190:191], v12 offset:3904
  ds_read_b128 v[196:199], v14 offset:4096
  v_mfma_f32_32x32x16_bf16 v[112:127], v[164:167], v[176:179], v[112:127]
  buffer_load_dwordx4 v9, s[36:39], s58 offen offset:2048 lds
  v_mfma_f32_32x32x16_bf16 v[144:159], v[168:171], v[176:179], v[144:159]
  buffer_load_dwordx4 v10, s[36:39], s58 offen offset:3072 lds
  s_add_u32 s58, s58, 128
  s_cmp_ge_u32 s58, s74
  s_cselect_b32 s63, 1280, 0
  s_sub_u32 s58, s58, s63
  s_waitcnt vmcnt(10) lgkmcnt(0)
  s_barrier
  v_mfma_f32_32x32x16_bf16 v[64:79], v[180:183], v[192:195], v[64:79]
  ds_read_b128 v[172:175], v15 offset:0
  ds_read_b64_tr_b16 v[160:161], v11 offset:12288
  v_mfma_f32_32x32x16_bf16 v[96:111], v[184:187], v[192:195], v[96:111]
  ds_read_b64_tr_b16 v[162:163], v11 offset:13056
  ds_read_b64_tr_b16 v[164:165], v11 offset:12320
  v_mfma_f32_32x32x16_bf16 v[128:143], v[188:191], v[192:195], v[128:143]
  ds_read_b64_tr_b16 v[166:167], v11 offset:13088
  ds_read_b64_tr_b16 v[168:169], v12 offset:12352
  v_mfma_f32_32x32x16_bf16 v[80:95], v[180:183], v[196:199], v[80:95]
  s_cbranch_vccz Lcs_36
  v_mfma_f32_16x16x32_bf16 v[216:219], v[180:183], v[228:231], v[216:219]
  v_mfma_f32_16x16x32_bf16 v[220:223], v[184:187], v[228:231], v[220:223]
  v_mfma_f32_16x16x32_bf16 v[224:227], v[188:191], v[228:231], v[224:227]
Lcs_36:
  ds_read_b64_tr_b16 v[170:171], v12 offset:13120
  ds_read_b128 v[176:179], v15 offset:4096
  v_mfma_f32_32x32x16_bf16 v[112:127], v[184:187], v[196:199], v[112:127]
  v_mfma_f32_32x32x16_bf16 v[144:159], v[188:191], v[196:199], v[144:159]
  s_waitcnt lgkmcnt(5)
  v_mfma_f32_32x32x16_bf16 v[64:79], v[160:163], v[172:175], v[64:79]
  ds_read_b128 v[192:195], v16 offset:0
  ds_read_b64_tr_b16 v[180:181], v11 offset:15360
  s_waitcnt lgkmcnt(5)
  v_mfma_f32_32x32x16_bf16 v[96:111], v[164:167], v[172:175], v[96:111]
  ds_read_b64_tr_b16 v[182:183], v11 offset:16128
  ds_read_b64_tr_b16 v[184:185], v11 offset:15392
  s_waitcnt lgkmcnt(5)
  v_mfma_f32_32x32x16_bf16 v[128:143], v[168:171], v[172:175], v[128:143]
  ds_read_b64_tr_b16 v[186:187], v11 offset:16160
  ds_read_b64_tr_b16 v[188:189], v12 offset:15424
  s_waitcnt lgkmcnt(6)
  v_mfma_f32_32x32x16_bf16 v[80:95], v[160:163], v[176:179], v[80:95]
  s_cbranch_vccnz Lcs_37
  v_mfma_f32_16x16x32_bf16 v[216:219], v[160:163], v[228:231], v[216:219]
  v_mfma_f32_16x16x32_bf16 v[220:223], v[164:167], v[228:231], v[220:223]
  v_mfma_f32_16x16x32_bf16 v[224:227], v[168:171], v[228:231], v[224:227]
Lcs_37:
  ds_read_b64_tr_b16 v[190:191], v12 offset:16192
  ds_read_b128 v[196:199], v16 offset:4096
  v_mfma_f32_32x32x16_bf16 v[112:127], v[164:167], v[176:179], v[112:127]
  v_mfma_f32_32x32x16_bf16 v[144:159], v[168:171], v[176:179], v[144:159]
  v_and_b32 v2, 31, v1
  s_lshl_b32 s61, s46, 7
  s_and_b32 s63, s56, 1
  s_lshl_b32 s63, s63, 6
  s_add_u32 s61, s61, s63
  v_add_u32 v2, s61, v2
  v_lshlrev_b32 v201, 4, v2
  v_add_u32 v201, 14155776, v201
  buffer_load_dwordx4 v[240:243], v201, s[32:35], 0 offen offset:0 sc1
  buffer_load_dwordx4 v[244:247], v201, s[32:35], 0 offen offset:512 sc1
  s_and_b32 s61, s56, 1
  s_cmp_eq_u32 s61, 1
  s_cselect_b64 vcc, -1, 0
  s_mov_b32 exec_lo, 0xffffff
  s_mov_b32 exec_hi, 0
  buffer_load_dword v202, v19, s[32:35], 0 offen sc1
  s_mov_b64 exec, -1
  s_waitcnt vmcnt(3) lgkmcnt(0)
  s_barrier
  v_mfma_f32_32x32x16_bf16 v[64:79], v[180:183], v[192:195], v[64:79]
  ds_read_b128 v[172:175], v13 offset:16384
  ds_read_b64_tr_b16 v[160:161], v11 offset:24576
  v_mfma_f32_32x32x16_bf16 v[96:111], v[184:187], v[192:195], v[96:111]
  ds_read_b64_tr_b16 v[162:163], v11 offset:25344
  ds_read_b64_tr_b16 v[164:165], v11 offset:24608
  v_mfma_f32_32x32x16_bf16 v[128:143], v[188:191], v[192:195], v[128:143]
  ds_read_b64_tr_b16 v[166:167], v11 offset:25376
  ds_read_b64_tr_b16 v[168:169], v12 offset:24640
  v_mfma_f32_32x32x16_bf16 v[80:95], v[180:183], v[196:199], v[80:95]
  s_cbranch_vccz Lcs_38
  v_mfma_f32_16x16x32_bf16 v[216:219], v[180:183], v[228:231], v[216:219]
  v_mfma_f32_16x16x32_bf16 v[220:223], v[184:187], v[228:231], v[220:223]
  v_mfma_f32_16x16x32_bf16 v[224:227], v[188:191], v[228:231], v[224:227]
Lcs_38:
  ds_read_b64_tr_b16 v[170:171], v12 offset:25408
  ds_read_b128 v[176:179], v13 offset:20480
  v_mfma_f32_32x32x16_bf16 v[112:127], v[184:187], v[196:199], v[112:127]
  v_mfma_f32_32x32x16_bf16 v[144:159], v[188:191], v[196:199], v[144:159]
  s_waitcnt lgkmcnt(5)
  v_mfma_f32_32x32x16_bf16 v[64:79], v[160:163], v[172:175], v[64:79]
  ds_read_b128 v[192:195], v14 offset:16384
  ds_read_b64_tr_b16 v[180:181], v11 offset:27648
  s_waitcnt lgkmcnt(5)
  v_mfma_f32_32x32x16_bf16 v[96:111], v[164:167], v[172:175], v[96:111]
  ds_read_b64_tr_b16 v[182:183], v11 offset:28416
  ds_read_b64_tr_b16 v[184:185], v11 offset:27680
  s_waitcnt lgkmcnt(5)
  v_mfma_f32_32x32x16_bf16 v[128:143], v[168:171], v[172:175], v[128:143]
  ds_read_b64_tr_b16 v[186:187], v11 offset:28448
  ds_read_b64_tr_b16 v[188:189], v12 offset:27712
  s_waitcnt lgkmcnt(6)
  v_mfma_f32_32x32x16_bf16 v[80:95], v[160:163], v[176:179], v[80:95]
  s_cbranch_vccnz Lcs_39
  v_mfma_f32_16x16x32_bf16 v[216:219], v[160:163], v[228:231], v[216:219]
  v_mfma_f32_16x16x32_bf16 v[220:223], v[164:167], v[228:231], v[220:223]
  v_mfma_f32_16x16x32_bf16 v[224:227], v[168:171], v[228:231], v[224:227]
Lcs_39:
  ds_read_b64_tr_b16 v[190:191], v12 offset:28480
  ds_read_b128 v[196:199], v14 offset:20480
  v_mfma_f32_32x32x16_bf16 v[112:127], v[164:167], v[176:179], v[112:127]
  v_mfma_f32_32x32x16_bf16 v[144:159], v[168:171], v[176:179], v[144:159]
  s_waitcnt vmcnt(3) lgkmcnt(0)
  s_barrier
  v_mfma_f32_32x32x16_bf16 v[64:79], v[180:183], v[192:195], v[64:79]
  ds_read_b128 v[172:175], v15 offset:16384
  ds_read_b64_tr_b16 v[160:161], v11 offset:36864
  v_mfma_f32_32x32x16_bf16 v[96:111], v[184:187], v[192:195], v[96:111]
  ds_read_b64_tr_b16 v[162:163], v11 offset:37632
  ds_read_b64_tr_b16 v[164:165], v11 offset:36896
  v_mfma_f32_32x32x16_bf16 v[128:143], v[188:191], v[192:195], v[128:143]
  ds_read_b64_tr_b16 v[166:167], v11 offset:37664
  ds_read_b64_tr_b16 v[168:169], v12 offset:36928
  v_mfma_f32_32x32x16_bf16 v[80:95], v[180:183], v[196:199], v[80:95]
  s_cbranch_vccz Lcs_40
  v_mfma_f32_16x16x32_bf16 v[216:219], v[180:183], v[228:231], v[216:219]
  v_mfma_f32_16x16x32_bf16 v[220:223], v[184:187], v[228:231], v[220:223]
  v_mfma_f32_16x16x32_bf16 v[224:227], v[188:191], v[228:231], v[224:227]
Lcs_40:
  ds_read_b64_tr_b16 v[170:171], v12 offset:37696
  ds_read_b128 v[176:179], v15 offset:20480
  v_mfma_f32_32x32x16_bf16 v[112:127], v[184:187], v[196:199], v[112:127]
  v_mfma_f32_32x32x16_bf16 v[144:159], v[188:191], v[196:199], v[144:159]
  s_waitcnt lgkmcnt(5)
  v_mfma_f32_32x32x16_bf16 v[64:79], v[160:163], v[172:175], v[64:79]
  ds_read_b128 v[192:195], v16 offset:16384
  ds_read_b64_tr_b16 v[180:181], v11 offset:39936
  s_waitcnt lgkmcnt(5)
  v_mfma_f32_32x32x16_bf16 v[96:111], v[164:167], v[172:175], v[96:111]
  ds_read_b64_tr_b16 v[182:183], v11 offset:40704
  ds_read_b64_tr_b16 v[184:185], v11 offset:39968
  s_waitcnt lgkmcnt(5)
  v_mfma_f32_32x32x16_bf16 v[128:143], v[168:171], v[172:175], v[128:143]
  ds_read_b64_tr_b16 v[186:187], v11 offset:40736
  ds_read_b64_tr_b16 v[188:189], v12 offset:40000
  s_waitcnt lgkmcnt(6)
  v_mfma_f32_32x32x16_bf16 v[80:95], v[160:163], v[176:179], v[80:95]
  s_cbranch_vccnz Lcs_41
  v_mfma_f32_16x16x32_bf16 v[216:219], v[160:163], v[228:231], v[216:219]
  v_mfma_f32_16x16x32_bf16 v[220:223], v[164:167], v[228:231], v[220:223]
  v_mfma_f32_16x16x32_bf16 v[224:227], v[168:171], v[228:231], v[224:227]
Lcs_41:
  ds_read_b64_tr_b16 v[190:191], v12 offset:40768
  ds_read_b128 v[196:199], v16 offset:20480
  v_mfma_f32_32x32x16_bf16 v[112:127], v[164:167], v[176:179], v[112:127]
  v_mfma_f32_32x32x16_bf16 v[144:159], v[168:171], v[176:179], v[144:159]
  s_waitcnt lgkmcnt(0)
  v_mfma_f32_32x32x16_bf16 v[64:79], v[180:183], v[192:195], v[64:79]
  v_mfma_f32_32x32x16_bf16 v[96:111], v[184:187], v[192:195], v[96:111]
  v_mfma_f32_32x32x16_bf16 v[128:143], v[188:191], v[192:195], v[128:143]
  v_mfma_f32_32x32x16_bf16 v[80:95], v[180:183], v[196:199], v[80:95]
  v_mfma_f32_32x32x16_bf16 v[112:127], v[184:187], v[196:199], v[112:127]
  v_mfma_f32_32x32x16_bf16 v[144:159], v[188:191], v[196:199], v[144:159]
  s_cbranch_vccz Lcs_42
  v_mfma_f32_16x16x32_bf16 v[216:219], v[180:183], v[228:231], v[216:219]
  v_mfma_f32_16x16x32_bf16 v[220:223], v[184:187], v[228:231], v[220:223]
  v_mfma_f32_16x16x32_bf16 v[224:227], v[188:191], v[228:231], v[224:227]
Lcs_42:
  s_setprio 3
  s_waitcnt vmcnt(0)
  s_mov_b32 s41, 0x40000
Lst_43:
  v_cmp_ne_u32 vcc, s40, v242
  s_nop 3
  s_mov_b64 s[44:45], vcc
  v_cmp_ne_u32 vcc, s40, v246
  s_nop 3
  s_or_b64 s[44:45], s[44:45], vcc
  s_cmp_lg_u64 s[44:45], 0
  s_cbranch_scc0 Lst_44
  s_sub_u32 s41, s41, 1
  s_cbranch_scc1 Lst_44
  s_sleep 4
  buffer_load_dwordx4 v[240:243], v201, s[32:35], 0 offen offset:0 sc1
  buffer_load_dwordx4 v[244:247], v201, s[32:35], 0 offen offset:512 sc1
  s_waitcnt vmcnt(0)
  s_branch Lst_43
Lst_44:
  v_and_b32 v2, 15, v1
  v_lshrrev_b32 v3, 4, v1
  v_lshlrev_b32 v3, 4, v3
  v_lshl_add_u32 v3, v2, 6, v3
  s_lshr_b32 s61, s56, 1
  s_lshl_b32 s61, s61, 1
  s_and_b32 s63, s56, 1
  s_add_u32 s61, s61, s63
  s_mul_i32 s61, s61, 384
  v_add_u32 v3, s61, v3
  s_mov_b32 exec_lo, 0x00030003
  s_mov_b32 exec_hi, 0x00030003
  ds_write_b128 v3, v[216:219] offset:0
  ds_write_b128 v3, v[220:223] offset:128
  ds_write_b128 v3, v[224:227] offset:256
  s_mov_b64 exec, -1
  s_waitcnt lgkmcnt(0)
  s_barrier
  v_bfe_u32 v3, v1, 4, 1
  v_lshlrev_b32 v3, 6, v3
  v_lshl_add_u32 v3, v2, 2, v3
  s_lshr_b32 s61, s56, 1
  s_mul_i32 s61, s61, 768
  v_add_u32 v3, s61, v3
  ds_read_b32 v208, v3 offset:0
  ds_read_b32 v209, v3 offset:384
  ds_read_b32 v210, v3 offset:128
  ds_read_b32 v211, v3 offset:512
  ds_read_b32 v212, v3 offset:256
  ds_read_b32 v213, v3 offset:640
  v_cmp_gt_u32 vcc, 32, v1
  s_waitcnt lgkmcnt(0)
  s_barrier
  s_lshr_b32 s65, s64, 1
  s_lshl_b32 s65, s65, 3
  s_add_u32 s65, s65, s48
  s_and_b32 s66, s64, 1
  s_lshl_b32 s66, s66, 2
  s_add_u32 s66, s66, s49
  s_mul_i32 s61, s56, 12288
  s_mul_i32 s63, s66, 245760
  s_add_u32 s63, s63, s61
  s_add_u32 s67, s63, 9437184
  s_add_u32 s68, s63, 9486336
  s_add_u32 s69, s63, 9535488
  s_add_u32 s70, s63, 9584640
  s_add_u32 s71, s63, 9633792
  v_lshlrev_b32 v4, 4, v1
  s_mul_i32 s76, s56, 20480
  s_mul_i32 s61, s49, 0
  s_mov_b32 s48, s61
  s_add_u32 s50, s48, 1024
  s_cmp_ge_u32 s50, 12288
  s_cselect_b32 s63, 12288, 0
  s_sub_u32 s50, s50, s63
  s_add_u32 s51, s50, 1024
  s_cmp_ge_u32 s51, 12288
  s_cselect_b32 s63, 12288, 0
  s_sub_u32 s51, s51, s63
  s_add_u32 s57, s51, 1024
  s_cmp_ge_u32 s57, 12288
  s_cselect_b32 s63, 12288, 0
  s_sub_u32 s57, s57, s63
  s_add_u32 s58, s57, 1024
  s_cmp_ge_u32 s58, 12288
  s_cselect_b32 s63, 12288, 0
  s_sub_u32 s58, s58, s63
  s_add_u32 s59, s58, 1024
  s_cmp_ge_u32 s59, 12288
  s_cselect_b32 s63, 12288, 0
  s_sub_u32 s59, s59, s63
  s_add_u32 s60, s59, 1024
  s_cmp_ge_u32 s60, 12288
  s_cselect_b32 s63, 12288, 0
  s_sub_u32 s60, s60, s63
  s_add_u32 s62, s60, 1024
  s_cmp_ge_u32 s62, 12288
  s_cselect_b32 s63, 12288, 0
  s_sub_u32 s62, s62, s63
  s_add_u32 s78, s62, 1024
  s_cmp_ge_u32 s78, 12288
  s_cselect_b32 s63, 12288, 0
  s_sub_u32 s78, s78, s63
  s_add_u32 s79, s78, 1024
  s_cmp_ge_u32 s79, 12288
  s_cselect_b32 s63, 12288, 0
  s_sub_u32 s79, s79, s63
  s_add_u32 s80, s79, 1024
  s_cmp_ge_u32 s80, 12288
  s_cselect_b32 s63, 12288, 0
  s_sub_u32 s80, s80, s63
  s_add_u32 s81, s80, 1024
  s_cmp_ge_u32 s81, 12288
  s_cselect_b32 s63, 12288, 0
  s_sub_u32 s81, s81, s63
  v_add_f32 v2, v208, v209
  v_cvt_pk_bf16_f32 v3, v2, v2
  v_and_b32 v3, 0xffff0000, v3
  v_sub_f32 v2, v2, v3
  v_cvt_pk_bf16_f32 v2, v3, v2
  v_cndmask_b32 v160, 0, v2, vcc
  v_mov_b32 v161, 0
  v_mov_b32 v162, 0
  v_mov_b32 v163, 0
  v_add_f32 v2, v210, v211
  v_cvt_pk_bf16_f32 v3, v2, v2
  v_and_b32 v3, 0xffff0000, v3
  v_sub_f32 v2, v2, v3
  v_cvt_pk_bf16_f32 v2, v3, v2
  v_cndmask_b32 v164, 0, v2, vcc
  v_mov_b32 v165, 0
  v_mov_b32 v166, 0
  v_mov_b32 v167, 0
  v_add_f32 v2, v212, v213
  v_cvt_pk_bf16_f32 v3, v2, v2
  v_and_b32 v3, 0xffff0000, v3
  v_sub_f32 v2, v2, v3
  v_cvt_pk_bf16_f32 v2, v3, v2
  v_cndmask_b32 v168, 0, v2, vcc
  v_mov_b32 v169, 0
  v_mov_b32 v170, 0
  v_mov_b32 v171, 0
  v_cvt_pk_bf16_f32 v2, v240, v240
  v_cndmask_b32 v172, 0, v2, vcc
  v_mov_b32 v173, 0
  v_mov_b32 v174, 0
  v_mov_b32 v175, 0
  v_cvt_pk_bf16_f32 v2, v244, v244
  v_cndmask_b32 v176, 0, v2, vcc
  v_mov_b32 v177, 0
  v_mov_b32 v178, 0
  v_mov_b32 v179, 0
  v_mfma_f32_32x32x16_bf16 v[64:79], v[160:163], v[172:175], v[64:79]
  v_mfma_f32_32x32x16_bf16 v[96:111], v[164:167], v[172:175], v[96:111]
  v_mfma_f32_32x32x16_bf16 v[128:143], v[168:171], v[172:175], v[128:143]
  v_mfma_f32_32x32x16_bf16 v[80:95], v[160:163], v[176:179], v[80:95]
  v_mfma_f32_32x32x16_bf16 v[112:127], v[164:167], v[176:179], v[112:127]
  v_mfma_f32_32x32x16_bf16 v[144:159], v[168:171], v[176:179], v[144:159]
  v_mul_f32 v214, 0xbfb8aa3b, v241
  v_mul_f32 v208, v241, v241
  v_rcp_f32 v208, v208
  v_mul_f32 v215, 0xbfb8aa3b, v245
  v_mul_f32 v209, v245, v245
  v_rcp_f32 v209, v209
  s_nop 0
  v_mul_f32 v216, v64, v214
  v_mul_f32 v217, v65, v214
  v_mul_f32 v218, v66, v214
  v_mul_f32 v219, v67, v214
  v_mul_f32 v220, v68, v214
  v_mul_f32 v221, v69, v214
  v_mul_f32 v222, v70, v214
  v_mul_f32 v223, v71, v214
  v_exp_f32 v216, v216
  v_exp_f32 v217, v217
  v_exp_f32 v218, v218
  v_exp_f32 v219, v219
  v_exp_f32 v220, v220
  v_exp_f32 v221, v221
  v_exp_f32 v222, v222
  v_exp_f32 v223, v223
  v_mul_f32 v64, v64, v72
  v_mul_f32 v65, v65, v73
  v_mul_f32 v66, v66, v74
  v_mul_f32 v67, v67, v75
  v_mul_f32 v68, v68, v76
  v_mul_f32 v69, v69, v77
  v_mul_f32 v70, v70, v78
  v_mul_f32 v71, v71, v79
  v_fma_f32 v216, v216, v208, v208
  v_fma_f32 v217, v217, v208, v208
  v_fma_f32 v218, v218, v208, v208
  v_fma_f32 v219, v219, v208, v208
  v_fma_f32 v220, v220, v208, v208
  v_fma_f32 v221, v221, v208, v208
  v_fma_f32 v222, v222, v208, v208
  v_fma_f32 v223, v223, v208, v208
  v_rcp_f32 v216, v216
  v_rcp_f32 v217, v217
  v_rcp_f32 v218, v218
  v_rcp_f32 v219, v219
  v_rcp_f32 v220, v220
  v_rcp_f32 v221, v221
  v_rcp_f32 v222, v222
  v_rcp_f32 v223, v223
  v_mul_f32 v216, v216, v64
  v_mul_f32 v217, v217, v65
  v_mul_f32 v218, v218, v66
  v_mul_f32 v219, v219, v67
  v_mul_f32 v220, v220, v68
  v_mul_f32 v221, v221, v69
  v_mul_f32 v222, v222, v70
  v_mul_f32 v223, v223, v71
  v_cvt_pk_bf16_f32 v232, v216, v217
  v_cvt_pk_bf16_f32 v233, v218, v219
  v_cvt_pk_bf16_f32 v234, v220, v221
  v_cvt_pk_bf16_f32 v235, v222, v223
  s_nop 0
  v_permlane32_swap_b32 v232, v234
  v_permlane32_swap_b32 v233, v235
  s_mov_b32 s61, 0
  buffer_store_dwordx4 v[232:235], v17, s[32:35], s61 offen sc1
  v_mul_f32 v216, v96, v214
  v_mul_f32 v217, v97, v214
  v_mul_f32 v218, v98, v214
  v_mul_f32 v219, v99, v214
  v_mul_f32 v220, v100, v214
  v_mul_f32 v221, v101, v214
  v_mul_f32 v222, v102, v214
  v_mul_f32 v223, v103, v214
  v_exp_f32 v216, v216
  v_exp_f32 v217, v217
  v_exp_f32 v218, v218
  v_exp_f32 v219, v219
  v_exp_f32 v220, v220
  v_exp_f32 v221, v221
  v_exp_f32 v222, v222
  v_exp_f32 v223, v223
  v_mul_f32 v96, v96, v104
  v_mul_f32 v97, v97, v105
  v_mul_f32 v98, v98, v106
  v_mul_f32 v99, v99, v107
  v_mul_f32 v100, v100, v108
  v_mul_f32 v101, v101, v109
  v_mul_f32 v102, v102, v110
  v_mul_f32 v103, v103, v111
  v_fma_f32 v216, v216, v208, v208
  v_fma_f32 v217, v217, v208, v208
  v_fma_f32 v218, v218, v208, v208
  v_fma_f32 v219, v219, v208, v208
  v_fma_f32 v220, v220, v208, v208
  v_fma_f32 v221, v221, v208, v208
  v_fma_f32 v222, v222, v208, v208
  v_fma_f32 v223, v223, v208, v208
  v_rcp_f32 v216, v216
  v_rcp_f32 v217, v217
  v_rcp_f32 v218, v218
  v_rcp_f32 v219, v219
  v_rcp_f32 v220, v220
  v_rcp_f32 v221, v221
  v_rcp_f32 v222, v222
  v_rcp_f32 v223, v223
  v_mul_f32 v216, v216, v96
  v_mul_f32 v217, v217, v97
  v_mul_f32 v218, v218, v98
  v_mul_f32 v219, v219, v99
  v_mul_f32 v220, v220, v100
  v_mul_f32 v221, v221, v101
  v_mul_f32 v222, v222, v102
  v_mul_f32 v223, v223, v103
  v_cvt_pk_bf16_f32 v236, v216, v217
  v_cvt_pk_bf16_f32 v237, v218, v219
  v_cvt_pk_bf16_f32 v238, v220, v221
  v_cvt_pk_bf16_f32 v239, v222, v223
  s_nop 0
  v_permlane32_swap_b32 v236, v238
  v_permlane32_swap_b32 v237, v239
  s_mov_b32 s61, 512
  buffer_store_dwordx4 v[236:239], v17, s[32:35], s61 offen sc1
  v_mul_f32 v216, v128, v214
  v_mul_f32 v217, v129, v214
  v_mul_f32 v218, v130, v214
  v_mul_f32 v219, v131, v214
  v_mul_f32 v220, v132, v214
  v_mul_f32 v221, v133, v214
  v_mul_f32 v222, v134, v214
  v_mul_f32 v223, v135, v214
  v_exp_f32 v216, v216
  v_exp_f32 v217, v217
  v_exp_f32 v218, v218
  v_exp_f32 v219, v219
  v_exp_f32 v220, v220
  v_exp_f32 v221, v221
  v_exp_f32 v222, v222
  v_exp_f32 v223, v223
  v_mul_f32 v128, v128, v136
  v_mul_f32 v129, v129, v137
  v_mul_f32 v130, v130, v138
  v_mul_f32 v131, v131, v139
  v_mul_f32 v132, v132, v140
  v_mul_f32 v133, v133, v141
  v_mul_f32 v134, v134, v142
  v_mul_f32 v135, v135, v143
  v_fma_f32 v216, v216, v208, v208
  v_fma_f32 v217, v217, v208, v208
  v_fma_f32 v218, v218, v208, v208
  v_fma_f32 v219, v219, v208, v208
  v_fma_f32 v220, v220, v208, v208
  v_fma_f32 v221, v221, v208, v208
  v_fma_f32 v222, v222, v208, v208
  v_fma_f32 v223, v223, v208, v208
  v_rcp_f32 v216, v216
  v_rcp_f32 v217, v217
  v_rcp_f32 v218, v218
  v_rcp_f32 v219, v219
  v_rcp_f32 v220, v220
  v_rcp_f32 v221, v221
  v_rcp_f32 v222, v222
  v_rcp_f32 v223, v223
  v_mul_f32 v216, v216, v128
  v_mul_f32 v217, v217, v129
  v_mul_f32 v218, v218, v130
  v_mul_f32 v219, v219, v131
  v_mul_f32 v220, v220, v132
  v_mul_f32 v221, v221, v133
  v_mul_f32 v222, v222, v134
  v_mul_f32 v223, v223, v135
  v_cvt_pk_bf16_f32 v232, v216, v217
  v_cvt_pk_bf16_f32 v233, v218, v219
  v_cvt_pk_bf16_f32 v234, v220, v221
  v_cvt_pk_bf16_f32 v235, v222, v223
  s_nop 0
  v_permlane32_swap_b32 v232, v234
  v_permlane32_swap_b32 v233, v235
  s_mov_b32 s61, 1024
  buffer_store_dwordx4 v[232:235], v17, s[32:35], s61 offen sc1
  v_mul_f32 v216, v80, v215
  v_mul_f32 v217, v81, v215
  v_mul_f32 v218, v82, v215
  v_mul_f32 v219, v83, v215
  v_mul_f32 v220, v84, v215
  v_mul_f32 v221, v85, v215
  v_mul_f32 v222, v86, v215
  v_mul_f32 v223, v87, v215
  v_exp_f32 v216, v216
  v_exp_f32 v217, v217
  v_exp_f32 v218, v218
  v_exp_f32 v219, v219
  v_exp_f32 v220, v220
  v_exp_f32 v221, v221
  v_exp_f32 v222, v222
  v_exp_f32 v223, v223
  v_mul_f32 v80, v80, v88
  v_mul_f32 v81, v81, v89
  v_mul_f32 v82, v82, v90
  v_mul_f32 v83, v83, v91
  v_mul_f32 v84, v84, v92
  v_mul_f32 v85, v85, v93
  v_mul_f32 v86, v86, v94
  v_mul_f32 v87, v87, v95
  v_fma_f32 v216, v216, v209, v209
  v_fma_f32 v217, v217, v209, v209
  v_fma_f32 v218, v218, v209, v209
  v_fma_f32 v219, v219, v209, v209
  v_fma_f32 v220, v220, v209, v209
  v_fma_f32 v221, v221, v209, v209
  v_fma_f32 v222, v222, v209, v209
  v_fma_f32 v223, v223, v209, v209
  v_rcp_f32 v216, v216
  v_rcp_f32 v217, v217
  v_rcp_f32 v218, v218
  v_rcp_f32 v219, v219
  v_rcp_f32 v220, v220
  v_rcp_f32 v221, v221
  v_rcp_f32 v222, v222
  v_rcp_f32 v223, v223
  v_mul_f32 v216, v216, v80
  v_mul_f32 v217, v217, v81
  v_mul_f32 v218, v218, v82
  v_mul_f32 v219, v219, v83
  v_mul_f32 v220, v220, v84
  v_mul_f32 v221, v221, v85
  v_mul_f32 v222, v222, v86
  v_mul_f32 v223, v223, v87
  v_cvt_pk_bf16_f32 v236, v216, v217
  v_cvt_pk_bf16_f32 v237, v218, v219
  v_cvt_pk_bf16_f32 v238, v220, v221
  v_cvt_pk_bf16_f32 v239, v222, v223
  s_nop 0
  v_permlane32_swap_b32 v236, v238
  v_permlane32_swap_b32 v237, v239
  s_mov_b32 s61, 98304
  buffer_store_dwordx4 v[236:239], v17, s[32:35], s61 offen sc1
  v_mul_f32 v216, v112, v215
  v_mul_f32 v217, v113, v215
  v_mul_f32 v218, v114, v215
  v_mul_f32 v219, v115, v215
  v_mul_f32 v220, v116, v215
  v_mul_f32 v221, v117, v215
  v_mul_f32 v222, v118, v215
  v_mul_f32 v223, v119, v215
  v_exp_f32 v216, v216
  v_exp_f32 v217, v217
  v_exp_f32 v218, v218
  v_exp_f32 v219, v219
  v_exp_f32 v220, v220
  v_exp_f32 v221, v221
  v_exp_f32 v222, v222
  v_exp_f32 v223, v223
  v_mul_f32 v112, v112, v120
  v_mul_f32 v113, v113, v121
  v_mul_f32 v114, v114, v122
  v_mul_f32 v115, v115, v123
  v_mul_f32 v116, v116, v124
  v_mul_f32 v117, v117, v125
  v_mul_f32 v118, v118, v126
  v_mul_f32 v119, v119, v127
  v_fma_f32 v216, v216, v209, v209
  v_fma_f32 v217, v217, v209, v209
  v_fma_f32 v218, v218, v209, v209
  v_fma_f32 v219, v219, v209, v209
  v_fma_f32 v220, v220, v209, v209
  v_fma_f32 v221, v221, v209, v209
  v_fma_f32 v222, v222, v209, v209
  v_fma_f32 v223, v223, v209, v209
  v_rcp_f32 v216, v216
  v_rcp_f32 v217, v217
  v_rcp_f32 v218, v218
  v_rcp_f32 v219, v219
  v_rcp_f32 v220, v220
  v_rcp_f32 v221, v221
  v_rcp_f32 v222, v222
  v_rcp_f32 v223, v223
  v_mul_f32 v216, v216, v112
  v_mul_f32 v217, v217, v113
  v_mul_f32 v218, v218, v114
  v_mul_f32 v219, v219, v115
  v_mul_f32 v220, v220, v116
  v_mul_f32 v221, v221, v117
  v_mul_f32 v222, v222, v118
  v_mul_f32 v223, v223, v119
  v_cvt_pk_bf16_f32 v232, v216, v217
  v_cvt_pk_bf16_f32 v233, v218, v219
  v_cvt_pk_bf16_f32 v234, v220, v221
  v_cvt_pk_bf16_f32 v235, v222, v223
  s_nop 0
  v_permlane32_swap_b32 v232, v234
  v_permlane32_swap_b32 v233, v235
  s_mov_b32 s61, 98816
  buffer_store_dwordx4 v[232:235], v17, s[32:35], s61 offen sc1
  v_mul_f32 v216, v144, v215
  v_mul_f32 v217, v145, v215
  v_mul_f32 v218, v146, v215
  v_mul_f32 v219, v147, v215
  v_mul_f32 v220, v148, v215
  v_mul_f32 v221, v149, v215
  v_mul_f32 v222, v150, v215
  v_mul_f32 v223, v151, v215
  v_exp_f32 v216, v216
  v_exp_f32 v217, v217
  v_exp_f32 v218, v218
  v_exp_f32 v219, v219
  v_exp_f32 v220, v220
  v_exp_f32 v221, v221
  v_exp_f32 v222, v222
  v_exp_f32 v223, v223
  v_mul_f32 v144, v144, v152
  v_mul_f32 v145, v145, v153
  v_mul_f32 v146, v146, v154
  v_mul_f32 v147, v147, v155
  v_mul_f32 v148, v148, v156
  v_mul_f32 v149, v149, v157
  v_mul_f32 v150, v150, v158
  v_mul_f32 v151, v151, v159
  v_fma_f32 v216, v216, v209, v209
  v_fma_f32 v217, v217, v209, v209
  v_fma_f32 v218, v218, v209, v209
  v_fma_f32 v219, v219, v209, v209
  v_fma_f32 v220, v220, v209, v209
  v_fma_f32 v221, v221, v209, v209
  v_fma_f32 v222, v222, v209, v209
  v_fma_f32 v223, v223, v209, v209
  v_rcp_f32 v216, v216
  v_rcp_f32 v217, v217
  v_rcp_f32 v218, v218
  v_rcp_f32 v219, v219
  v_rcp_f32 v220, v220
  v_rcp_f32 v221, v221
  v_rcp_f32 v222, v222
  v_rcp_f32 v223, v223
  v_mul_f32 v216, v216, v144
  v_mul_f32 v217, v217, v145
  v_mul_f32 v218, v218, v146
  v_mul_f32 v219, v219, v147
  v_mul_f32 v220, v220, v148
  v_mul_f32 v221, v221, v149
  v_mul_f32 v222, v222, v150
  v_mul_f32 v223, v223, v151
  v_cvt_pk_bf16_f32 v236, v216, v217
  v_cvt_pk_bf16_f32 v237, v218, v219
  v_cvt_pk_bf16_f32 v238, v220, v221
  v_cvt_pk_bf16_f32 v239, v222, v223
  s_nop 0
  v_permlane32_swap_b32 v236, v238
  v_permlane32_swap_b32 v237, v239
  s_mov_b32 s61, 99328
  buffer_store_dwordx4 v[236:239], v17, s[32:35], s61 offen sc1
  s_mul_i32 s63, s65, 196608
  s_mul_i32 s61, s56, 12288
  s_add_u32 s63, s63, s61
  s_add_u32 s63, s63, 3145728
  s_add_u32 s72, s56, 0
  s_and_b32 s72, s72, 3
  s_mul_i32 s72, s72, 49152
  s_add_u32 s72, s72, s63
  s_add_u32 s73, s56, 1
  s_and_b32 s73, s73, 3
  s_mul_i32 s73, s73, 49152
  s_add_u32 s73, s73, s63
  s_add_u32 s74, s56, 2
  s_and_b32 s74, s74, 3
  s_mul_i32 s74, s74, 49152
  s_add_u32 s74, s74, s63
  s_add_u32 s75, s56, 3
  s_and_b32 s75, s75, 3
  s_mul_i32 s75, s75, 49152
  s_add_u32 s75, s75, s63
  s_mov_b32 exec_lo, 0xffffff
  s_mov_b32 exec_hi, 0
  v_cmp_ne_u32 vcc, s40, v202
  s_nop 3
  s_mov_b64 s[44:45], vcc
  s_cmp_lg_u64 s[44:45], 0
  s_mov_b64 exec, -1
  s_cbranch_scc0 Lok_45
  s_mov_b32 exec_lo, 0xffffff
  s_mov_b32 exec_hi, 0x0
  s_mov_b32 s41, 0x40000
  s_branch Lpf_48
Lpoll_46:
  s_sleep 4
Lpf_48:
  buffer_load_dword v202, v19, s[32:35], 0 offen sc1
  s_sub_u32 s41, s41, 1
  s_cbranch_scc1 Lpout_47
  s_waitcnt vmcnt(0)
  v_cmp_ne_u32 vcc, s40, v202
  s_nop 3
  s_mov_b64 s[44:45], vcc
  s_cmp_lg_u64 s[44:45], 0
  s_cbranch_scc1 Lpoll_46
Lpout_47:
  s_waitcnt vmcnt(0)
  s_mov_b64 exec, -1
Lok_45:
  s_barrier
  s_add_u32 s77, s67, s48
  buffer_load_dwordx4 v[92:95], v4, s[32:35], s77 offen sc1
  s_add_u32 s77, s68, s48
  buffer_load_dwordx4 v[96:99], v4, s[32:35], s77 offen sc1
  s_add_u32 s77, s69, s48
  buffer_load_dwordx4 v[100:103], v4, s[32:35], s77 offen sc1
  s_add_u32 s77, s70, s48
  buffer_load_dwordx4 v[104:107], v4, s[32:35], s77 offen sc1
  s_add_u32 s77, s71, s48
  buffer_load_dwordx4 v[108:111], v4, s[32:35], s77 offen sc1
  s_add_u32 s77, s67, s50
  buffer_load_dwordx4 v[112:115], v4, s[32:35], s77 offen sc1
  s_add_u32 s77, s68, s50
  buffer_load_dwordx4 v[116:119], v4, s[32:35], s77 offen sc1
  s_add_u32 s77, s69, s50
  buffer_load_dwordx4 v[120:123], v4, s[32:35], s77 offen sc1
  s_add_u32 s77, s70, s50
  buffer_load_dwordx4 v[124:127], v4, s[32:35], s77 offen sc1
  s_add_u32 s77, s71, s50
  buffer_load_dwordx4 v[128:131], v4, s[32:35], s77 offen sc1
  s_waitcnt vmcnt(10)
  s_lshl_b32 s61, s46, 4
  s_add_u32 s61, s61, s47
  s_lshl_b32 s61, s61, 2
  s_add_u32 s61, s61, s56
  s_lshl_b32 s61, s61, 6
  s_add_u32 s61, s61, 14811136
  v_mov_b32 v2, 0
  v_mov_b32 v3, s40
  s_mov_b64 exec, 1
  buffer_store_dword v3, v2, s[32:35], s61 offen sc1
  s_mov_b64 exec, -1
  s_add_u32 s77, s67, s51
  buffer_load_dwordx4 v[132:135], v4, s[32:35], s77 offen sc1
  s_add_u32 s77, s68, s51
  buffer_load_dwordx4 v[136:139], v4, s[32:35], s77 offen sc1
  s_add_u32 s77, s69, s51
  buffer_load_dwordx4 v[140:143], v4, s[32:35], s77 offen sc1
  s_add_u32 s77, s70, s51
  buffer_load_dwordx4 v[144:147], v4, s[32:35], s77 offen sc1
  s_add_u32 s77, s71, s51
  buffer_load_dwordx4 v[148:151], v4, s[32:35], s77 offen sc1
  s_add_u32 s77, s67, s57
  buffer_load_dwordx4 v[152:155], v4, s[32:35], s77 offen sc1
  s_add_u32 s77, s68, s57
  buffer_load_dwordx4 v[156:159], v4, s[32:35], s77 offen sc1
  s_add_u32 s77, s69, s57
  buffer_load_dwordx4 v[160:163], v4, s[32:35], s77 offen sc1
  s_add_u32 s77, s70, s57
  buffer_load_dwordx4 v[164:167], v4, s[32:35], s77 offen sc1
  s_add_u32 s77, s71, s57
  buffer_load_dwordx4 v[168:171], v4, s[32:35], s77 offen sc1
  s_add_u32 s77, s67, s58
  buffer_load_dwordx4 v[172:175], v4, s[32:35], s77 offen sc1
  s_add_u32 s77, s68, s58
  buffer_load_dwordx4 v[176:179], v4, s[32:35], s77 offen sc1
  s_add_u32 s77, s69, s58
  buffer_load_dwordx4 v[180:183], v4, s[32:35], s77 offen sc1
  s_add_u32 s77, s70, s58
  buffer_load_dwordx4 v[184:187], v4, s[32:35], s77 offen sc1
  s_add_u32 s77, s71, s58
  buffer_load_dwordx4 v[188:191], v4, s[32:35], s77 offen sc1
  s_add_u32 m0, s76, 0
  s_add_u32 s77, s67, s78
  buffer_load_dwordx4 v4, s[32:35], s77 offen sc1 lds
  s_add_u32 m0, s76, 1024
  s_add_u32 s77, s67, s79
  buffer_load_dwordx4 v4, s[32:35], s77 offen sc1 lds
  s_add_u32 m0, s76, 2048
  s_add_u32 s77, s67, s80
  buffer_load_dwordx4 v4, s[32:35], s77 offen sc1 lds
  s_add_u32 m0, s76, 3072
  s_add_u32 s77, s67, s81
  buffer_load_dwordx4 v4, s[32:35], s77 offen sc1 lds
  s_add_u32 m0, s76, 4096
  s_add_u32 s77, s68, s78
  buffer_load_dwordx4 v4, s[32:35], s77 offen sc1 lds
  s_add_u32 m0, s76, 5120
  s_add_u32 s77, s68, s79
  buffer_load_dwordx4 v4, s[32:35], s77 offen sc1 lds
  s_add_u32 m0, s76, 6144
  s_add_u32 s77, s68, s80
  buffer_load_dwordx4 v4, s[32:35], s77 offen sc1 lds
  s_add_u32 m0, s76, 7168
  s_add_u32 s77, s68, s81
  buffer_load_dwordx4 v4, s[32:35], s77 offen sc1 lds
  s_add_u32 m0, s76, 8192
  s_add_u32 s77, s69, s78
  buffer_load_dwordx4 v4, s[32:35], s77 offen sc1 lds
  s_add_u32 m0, s76, 9216
  s_add_u32 s77, s69, s79
  buffer_load_dwordx4 v4, s[32:35], s77 offen sc1 lds
  s_add_u32 m0, s76, 10240
  s_add_u32 s77, s69, s80
  buffer_load_dwordx4 v4, s[32:35], s77 offen sc1 lds
  s_add_u32 m0, s76, 11264
  s_add_u32 s77, s69, s81
  buffer_load_dwordx4 v4, s[32:35], s77 offen sc1 lds
  s_add_u32 m0, s76, 12288
  s_add_u32 s77, s70, s78
  buffer_load_dwordx4 v4, s[32:35], s77 offen sc1 lds
  s_add_u32 m0, s76, 13312
  s_add_u32 s77, s70, s79
  buffer_load_dwordx4 v4, s[32:35], s77 offen sc1 lds
  s_add_u32 m0, s76, 14336
  s_add_u32 s77, s70, s80
  buffer_load_dwordx4 v4, s[32:35], s77 offen sc1 lds
  s_add_u32 m0, s76, 15360
  s_add_u32 s77, s70, s81
  buffer_load_dwordx4 v4, s[32:35], s77 offen sc1 lds
  s_add_u32 m0, s76, 16384
  s_add_u32 s77, s71, s78
  buffer_load_dwordx4 v4, s[32:35], s77 offen sc1 lds
  s_add_u32 m0, s76, 17408
  s_add_u32 s77, s71, s79
  buffer_load_dwordx4 v4, s[32:35], s77 offen sc1 lds
  s_add_u32 m0, s76, 18432
  s_add_u32 s77, s71, s80
  buffer_load_dwordx4 v4, s[32:35], s77 offen sc1 lds
  s_add_u32 m0, s76, 19456
  s_add_u32 s77, s71, s81
  buffer_load_dwordx4 v4, s[32:35], s77 offen sc1 lds
  v_and_b32 v2, 15, v1
  s_lshl_b32 s61, s65, 6
  s_lshl_b32 s63, s56, 4
  s_add_u32 s61, s61, s63
  v_add_u32 v2, s61, v2
  v_lshrrev_b32 v3, 4, v1
  v_mul_u32_u24 v6, 1280, v2
  v_lshl_add_u32 v6, v3, 3, v6
  s_mul_i32 s61, s66, 160
  v_add_u32 v6, s61, v6
  v_lshlrev_b32 v7, 14, v3
  v_lshl_add_u32 v7, v2, 1, v7
  s_mul_i32 s61, s66, 327680
  s_add_u32 s61, s61, 11534336
  v_add_u32 v7, s61, v7
  s_lshr_b32 s61, s65, 1
  s_lshl_b32 s61, s61, 6
  s_and_b32 s63, s65, 1
  s_add_u32 s61, s61, s63
  v_bfe_u32 v2, v1, 1, 4
  v_lshlrev_b32 v2, 2, v2
  v_and_b32 v3, 1, v1
  v_lshl_add_u32 v2, v3, 1, v2
  v_add_u32 v2, s61, v2
  v_lshlrev_b32 v2, 6, v2
  v_add_u32 v8, 14811136, v2
  s_mul_i32 s61, s66, 1280
  s_add_u32 s61, s61, 14745600
  v_min_u32 v2, 19, v1
  v_lshlrev_b32 v2, 6, v2
  v_add_u32 v9, s61, v2
  v_add_u32 v11, s76, v4
  s_cmp_lg_u32 s56, 0
  s_cbranch_scc1 Lhp_49
  s_mov_b32 exec_lo, 0xffffffff
  s_mov_b32 exec_hi, 0x0
  s_mov_b32 s41, 0x40000
  s_branch Lpf_52
Lpoll_50:
  s_sleep 2
Lpf_52:
  buffer_load_dword v10, v8, s[32:35], 0 offen sc1
  s_sub_u32 s41, s41, 1
  s_cbranch_scc1 Lpout_51
  s_waitcnt vmcnt(0)
  v_cmp_ne_u32 vcc, s40, v10
  s_nop 3
  s_mov_b64 s[44:45], vcc
  s_cmp_lg_u64 s[44:45], 0
  s_cbranch_scc1 Lpoll_50
Lpout_51:
  s_waitcnt vmcnt(0)
  s_mov_b64 exec, -1
Lhp_49:
  s_waitcnt vmcnt(0)
  s_barrier
  s_add_u32 s77, s72, s48
  buffer_load_dwordx4 v[192:195], v4, s[32:35], s77 offen sc1
  s_add_u32 s77, s73, s48
  buffer_load_dwordx4 v[196:199], v4, s[32:35], s77 offen sc1
  s_add_u32 s77, s74, s48
  buffer_load_dwordx4 v[200:203], v4, s[32:35], s77 offen sc1
  s_add_u32 s77, s75, s48
  buffer_load_dwordx4 v[204:207], v4, s[32:35], s77 offen sc1
  s_add_u32 s77, s72, s50
  buffer_load_dwordx4 v[208:211], v4, s[32:35], s77 offen sc1
  s_add_u32 s77, s73, s50
  buffer_load_dwordx4 v[212:215], v4, s[32:35], s77 offen sc1
  s_add_u32 s77, s74, s50
  buffer_load_dwordx4 v[216:219], v4, s[32:35], s77 offen sc1
  s_add_u32 s77, s75, s50
  buffer_load_dwordx4 v[220:223], v4, s[32:35], s77 offen sc1
  s_add_u32 s77, s72, s51
  buffer_load_dwordx4 v[224:227], v4, s[32:35], s77 offen sc1
  s_add_u32 s77, s73, s51
  buffer_load_dwordx4 v[228:231], v4, s[32:35], s77 offen sc1
  s_add_u32 s77, s74, s51
  buffer_load_dwordx4 v[232:235], v4, s[32:35], s77 offen sc1
  s_add_u32 s77, s75, s51
  buffer_load_dwordx4 v[236:239], v4, s[32:35], s77 offen sc1
  s_add_u32 s77, s72, s57
  buffer_load_dwordx4 v[240:243], v4, s[32:35], s77 offen sc1
  s_add_u32 s77, s73, s57
  buffer_load_dwordx4 v[244:247], v4, s[32:35], s77 offen sc1
  s_add_u32 s77, s74, s57
  buffer_load_dwordx4 v[248:251], v4, s[32:35], s77 offen sc1
  s_add_u32 s77, s75, s57
  buffer_load_dwordx4 v[252:255], v4, s[32:35], s77 offen sc1
  s_waitcnt vmcnt(12)
  v_mfma_f32_16x16x32_bf16 v[12:15], v[92:95], v[192:195], 0
  v_mfma_f32_16x16x32_bf16 v[16:19], v[92:95], v[196:199], 0
  v_mfma_f32_16x16x32_bf16 v[20:23], v[92:95], v[200:203], 0
  v_mfma_f32_16x16x32_bf16 v[24:27], v[92:95], v[204:207], 0
  s_add_u32 s77, s67, s59
  buffer_load_dwordx4 v[92:95], v4, s[32:35], s77 offen sc1
  v_mfma_f32_16x16x32_bf16 v[28:31], v[96:99], v[192:195], 0
  v_mfma_f32_16x16x32_bf16 v[32:35], v[96:99], v[196:199], 0
  v_mfma_f32_16x16x32_bf16 v[36:39], v[96:99], v[200:203], 0
  v_mfma_f32_16x16x32_bf16 v[40:43], v[96:99], v[204:207], 0
  s_add_u32 s77, s68, s59
  buffer_load_dwordx4 v[96:99], v4, s[32:35], s77 offen sc1
  v_mfma_f32_16x16x32_bf16 v[44:47], v[100:103], v[192:195], 0
  v_mfma_f32_16x16x32_bf16 v[48:51], v[100:103], v[196:199], 0
  v_mfma_f32_16x16x32_bf16 v[52:55], v[100:103], v[200:203], 0
  v_mfma_f32_16x16x32_bf16 v[56:59], v[100:103], v[204:207], 0
  s_add_u32 s77, s69, s59
  buffer_load_dwordx4 v[100:103], v4, s[32:35], s77 offen sc1
  v_mfma_f32_16x16x32_bf16 v[60:63], v[104:107], v[192:195], 0
  v_mfma_f32_16x16x32_bf16 v[64:67], v[104:107], v[196:199], 0
  v_mfma_f32_16x16x32_bf16 v[68:71], v[104:107], v[200:203], 0
  v_mfma_f32_16x16x32_bf16 v[72:75], v[104:107], v[204:207], 0
  s_add_u32 s77, s70, s59
  buffer_load_dwordx4 v[104:107], v4, s[32:35], s77 offen sc1
  v_mfma_f32_16x16x32_bf16 v[76:79], v[108:111], v[192:195], 0
  v_mfma_f32_16x16x32_bf16 v[80:83], v[108:111], v[196:199], 0
  v_mfma_f32_16x16x32_bf16 v[84:87], v[108:111], v[200:203], 0
  v_mfma_f32_16x16x32_bf16 v[88:91], v[108:111], v[204:207], 0
  s_add_u32 s77, s71, s59
  buffer_load_dwordx4 v[108:111], v4, s[32:35], s77 offen sc1
  s_waitcnt vmcnt(13)
  v_mfma_f32_16x16x32_bf16 v[12:15], v[112:115], v[208:211], v[12:15]
  v_mfma_f32_16x16x32_bf16 v[16:19], v[112:115], v[212:215], v[16:19]
  s_add_u32 s77, s72, s58
  buffer_load_dwordx4 v[192:195], v4, s[32:35], s77 offen sc1
  v_mfma_f32_16x16x32_bf16 v[20:23], v[112:115], v[216:219], v[20:23]
  v_mfma_f32_16x16x32_bf16 v[24:27], v[112:115], v[220:223], v[24:27]
  s_add_u32 s77, s67, s60
  buffer_load_dwordx4 v[112:115], v4, s[32:35], s77 offen sc1
  v_mfma_f32_16x16x32_bf16 v[28:31], v[116:119], v[208:211], v[28:31]
  v_mfma_f32_16x16x32_bf16 v[32:35], v[116:119], v[212:215], v[32:35]
  s_add_u32 s77, s73, s58
  buffer_load_dwordx4 v[196:199], v4, s[32:35], s77 offen sc1
  v_mfma_f32_16x16x32_bf16 v[36:39], v[116:119], v[216:219], v[36:39]
  v_mfma_f32_16x16x32_bf16 v[40:43], v[116:119], v[220:223], v[40:43]
  s_add_u32 s77, s68, s60
  buffer_load_dwordx4 v[116:119], v4, s[32:35], s77 offen sc1
  v_mfma_f32_16x16x32_bf16 v[44:47], v[120:123], v[208:211], v[44:47]
  v_mfma_f32_16x16x32_bf16 v[48:51], v[120:123], v[212:215], v[48:51]
  s_add_u32 s77, s74, s58
  buffer_load_dwordx4 v[200:203], v4, s[32:35], s77 offen sc1
  v_mfma_f32_16x16x32_bf16 v[52:55], v[120:123], v[216:219], v[52:55]
  v_mfma_f32_16x16x32_bf16 v[56:59], v[120:123], v[220:223], v[56:59]
  s_add_u32 s77, s69, s60
  buffer_load_dwordx4 v[120:123], v4, s[32:35], s77 offen sc1
  v_mfma_f32_16x16x32_bf16 v[60:63], v[124:127], v[208:211], v[60:63]
  v_mfma_f32_16x16x32_bf16 v[64:67], v[124:127], v[212:215], v[64:67]
  s_add_u32 s77, s75, s58
  buffer_load_dwordx4 v[204:207], v4, s[32:35], s77 offen sc1
  v_mfma_f32_16x16x32_bf16 v[68:71], v[124:127], v[216:219], v[68:71]
  v_mfma_f32_16x16x32_bf16 v[72:75], v[124:127], v[220:223], v[72:75]
  s_add_u32 s77, s70, s60
  buffer_load_dwordx4 v[124:127], v4, s[32:35], s77 offen sc1
  v_mfma_f32_16x16x32_bf16 v[76:79], v[128:131], v[208:211], v[76:79]
  v_mfma_f32_16x16x32_bf16 v[80:83], v[128:131], v[212:215], v[80:83]
  v_mfma_f32_16x16x32_bf16 v[84:87], v[128:131], v[216:219], v[84:87]
  v_mfma_f32_16x16x32_bf16 v[88:91], v[128:131], v[220:223], v[88:91]
  s_add_u32 s77, s71, s60
  buffer_load_dwordx4 v[128:131], v4, s[32:35], s77 offen sc1
  s_waitcnt vmcnt(18)
  v_mfma_f32_16x16x32_bf16 v[12:15], v[132:135], v[224:227], v[12:15]
  v_mfma_f32_16x16x32_bf16 v[16:19], v[132:135], v[228:231], v[16:19]
  s_add_u32 s77, s72, s59
  buffer_load_dwordx4 v[208:211], v4, s[32:35], s77 offen sc1
  v_mfma_f32_16x16x32_bf16 v[20:23], v[132:135], v[232:235], v[20:23]
  v_mfma_f32_16x16x32_bf16 v[24:27], v[132:135], v[236:239], v[24:27]
  s_add_u32 s77, s67, s62
  buffer_load_dwordx4 v[132:135], v4, s[32:35], s77 offen sc1
  v_mfma_f32_16x16x32_bf16 v[28:31], v[136:139], v[224:227], v[28:31]
  v_mfma_f32_16x16x32_bf16 v[32:35], v[136:139], v[228:231], v[32:35]
  s_add_u32 s77, s73, s59
  buffer_load_dwordx4 v[212:215], v4, s[32:35], s77 offen sc1
  v_mfma_f32_16x16x32_bf16 v[36:39], v[136:139], v[232:235], v[36:39]
  v_mfma_f32_16x16x32_bf16 v[40:43], v[136:139], v[236:239], v[40:43]
  s_add_u32 s77, s68, s62
  buffer_load_dwordx4 v[136:139], v4, s[32:35], s77 offen sc1
  v_mfma_f32_16x16x32_bf16 v[44:47], v[140:143], v[224:227], v[44:47]
  v_mfma_f32_16x16x32_bf16 v[48:51], v[140:143], v[228:231], v[48:51]
  s_add_u32 s77, s74, s59
  buffer_load_dwordx4 v[216:219], v4, s[32:35], s77 offen sc1
  v_mfma_f32_16x16x32_bf16 v[52:55], v[140:143], v[232:235], v[52:55]
  v_mfma_f32_16x16x32_bf16 v[56:59], v[140:143], v[236:239], v[56:59]
  s_add_u32 s77, s69, s62
  buffer_load_dwordx4 v[140:143], v4, s[32:35], s77 offen sc1
  v_mfma_f32_16x16x32_bf16 v[60:63], v[144:147], v[224:227], v[60:63]
  v_mfma_f32_16x16x32_bf16 v[64:67], v[144:147], v[228:231], v[64:67]
  s_add_u32 s77, s75, s59
  buffer_load_dwordx4 v[220:223], v4, s[32:35], s77 offen sc1
  v_mfma_f32_16x16x32_bf16 v[68:71], v[144:147], v[232:235], v[68:71]
  v_mfma_f32_16x16x32_bf16 v[72:75], v[144:147], v[236:239], v[72:75]
  s_add_u32 s77, s70, s62
  buffer_load_dwordx4 v[144:147], v4, s[32:35], s77 offen sc1
  v_mfma_f32_16x16x32_bf16 v[76:79], v[148:151], v[224:227], v[76:79]
  v_mfma_f32_16x16x32_bf16 v[80:83], v[148:151], v[228:231], v[80:83]
  v_mfma_f32_16x16x32_bf16 v[84:87], v[148:151], v[232:235], v[84:87]
  v_mfma_f32_16x16x32_bf16 v[88:91], v[148:151], v[236:239], v[88:91]
  s_add_u32 s77, s71, s62
  buffer_load_dwordx4 v[148:151], v4, s[32:35], s77 offen sc1
  s_waitcnt vmcnt(23)
  v_mfma_f32_16x16x32_bf16 v[12:15], v[152:155], v[240:243], v[12:15]
  v_mfma_f32_16x16x32_bf16 v[16:19], v[152:155], v[244:247], v[16:19]
  s_add_u32 s77, s72, s60
  buffer_load_dwordx4 v[224:227], v4, s[32:35], s77 offen sc1
  v_mfma_f32_16x16x32_bf16 v[20:23], v[152:155], v[248:251], v[20:23]
  v_mfma_f32_16x16x32_bf16 v[24:27], v[152:155], v[252:255], v[24:27]
  ds_read_b128 v[152:155], v11 offset:0
  v_mfma_f32_16x16x32_bf16 v[28:31], v[156:159], v[240:243], v[28:31]
  v_mfma_f32_16x16x32_bf16 v[32:35], v[156:159], v[244:247], v[32:35]
  s_add_u32 s77, s73, s60
  buffer_load_dwordx4 v[228:231], v4, s[32:35], s77 offen sc1
  v_mfma_f32_16x16x32_bf16 v[36:39], v[156:159], v[248:251], v[36:39]
  v_mfma_f32_16x16x32_bf16 v[40:43], v[156:159], v[252:255], v[40:43]
  ds_read_b128 v[156:159], v11 offset:4096
  v_mfma_f32_16x16x32_bf16 v[44:47], v[160:163], v[240:243], v[44:47]
  v_mfma_f32_16x16x32_bf16 v[48:51], v[160:163], v[244:247], v[48:51]
  s_add_u32 s77, s74, s60
  buffer_load_dwordx4 v[232:235], v4, s[32:35], s77 offen sc1
  v_mfma_f32_16x16x32_bf16 v[52:55], v[160:163], v[248:251], v[52:55]
  v_mfma_f32_16x16x32_bf16 v[56:59], v[160:163], v[252:255], v[56:59]
  ds_read_b128 v[160:163], v11 offset:8192
  v_mfma_f32_16x16x32_bf16 v[60:63], v[164:167], v[240:243], v[60:63]
  v_mfma_f32_16x16x32_bf16 v[64:67], v[164:167], v[244:247], v[64:67]
  s_add_u32 s77, s75, s60
  buffer_load_dwordx4 v[236:239], v4, s[32:35], s77 offen sc1
  v_mfma_f32_16x16x32_bf16 v[68:71], v[164:167], v[248:251], v[68:71]
  v_mfma_f32_16x16x32_bf16 v[72:75], v[164:167], v[252:255], v[72:75]
  ds_read_b128 v[164:167], v11 offset:12288
  v_mfma_f32_16x16x32_bf16 v[76:79], v[168:171], v[240:243], v[76:79]
  v_mfma_f32_16x16x32_bf16 v[80:83], v[168:171], v[244:247], v[80:83]
  v_mfma_f32_16x16x32_bf16 v[84:87], v[168:171], v[248:251], v[84:87]
  v_mfma_f32_16x16x32_bf16 v[88:91], v[168:171], v[252:255], v[88:91]
  ds_read_b128 v[168:171], v11 offset:16384
  s_waitcnt vmcnt(15)
  v_mfma_f32_16x16x32_bf16 v[12:15], v[172:175], v[192:195], v[12:15]
  v_mfma_f32_16x16x32_bf16 v[16:19], v[172:175], v[196:199], v[16:19]
  s_add_u32 s77, s72, s62
  buffer_load_dwordx4 v[240:243], v4, s[32:35], s77 offen sc1
  v_mfma_f32_16x16x32_bf16 v[20:23], v[172:175], v[200:203], v[20:23]
  v_mfma_f32_16x16x32_bf16 v[24:27], v[172:175], v[204:207], v[24:27]
  ds_read_b128 v[172:175], v11 offset:1024
  v_mfma_f32_16x16x32_bf16 v[28:31], v[176:179], v[192:195], v[28:31]
  v_mfma_f32_16x16x32_bf16 v[32:35], v[176:179], v[196:199], v[32:35]
  s_add_u32 s77, s73, s62
  buffer_load_dwordx4 v[244:247], v4, s[32:35], s77 offen sc1
  v_mfma_f32_16x16x32_bf16 v[36:39], v[176:179], v[200:203], v[36:39]
  v_mfma_f32_16x16x32_bf16 v[40:43], v[176:179], v[204:207], v[40:43]
  ds_read_b128 v[176:179], v11 offset:5120
  v_mfma_f32_16x16x32_bf16 v[44:47], v[180:183], v[192:195], v[44:47]
  v_mfma_f32_16x16x32_bf16 v[48:51], v[180:183], v[196:199], v[48:51]
  s_add_u32 s77, s74, s62
  buffer_load_dwordx4 v[248:251], v4, s[32:35], s77 offen sc1
  v_mfma_f32_16x16x32_bf16 v[52:55], v[180:183], v[200:203], v[52:55]
  v_mfma_f32_16x16x32_bf16 v[56:59], v[180:183], v[204:207], v[56:59]
  ds_read_b128 v[180:183], v11 offset:9216
  v_mfma_f32_16x16x32_bf16 v[60:63], v[184:187], v[192:195], v[60:63]
  v_mfma_f32_16x16x32_bf16 v[64:67], v[184:187], v[196:199], v[64:67]
  s_add_u32 s77, s75, s62
  buffer_load_dwordx4 v[252:255], v4, s[32:35], s77 offen sc1
  v_mfma_f32_16x16x32_bf16 v[68:71], v[184:187], v[200:203], v[68:71]
  v_mfma_f32_16x16x32_bf16 v[72:75], v[184:187], v[204:207], v[72:75]
  ds_read_b128 v[184:187], v11 offset:13312
  v_mfma_f32_16x16x32_bf16 v[76:79], v[188:191], v[192:195], v[76:79]
  v_mfma_f32_16x16x32_bf16 v[80:83], v[188:191], v[196:199], v[80:83]
  v_mfma_f32_16x16x32_bf16 v[84:87], v[188:191], v[200:203], v[84:87]
  v_mfma_f32_16x16x32_bf16 v[88:91], v[188:191], v[204:207], v[88:91]
  ds_read_b128 v[188:191], v11 offset:17408
  s_waitcnt vmcnt(10)
  v_mfma_f32_16x16x32_bf16 v[12:15], v[92:95], v[208:211], v[12:15]
  v_mfma_f32_16x16x32_bf16 v[16:19], v[92:95], v[212:215], v[16:19]
  s_add_u32 s77, s72, s78
  buffer_load_dwordx4 v[192:195], v4, s[32:35], s77 offen sc1
  v_mfma_f32_16x16x32_bf16 v[20:23], v[92:95], v[216:219], v[20:23]
  v_mfma_f32_16x16x32_bf16 v[24:27], v[92:95], v[220:223], v[24:27]
  ds_read_b128 v[92:95], v11 offset:2048
  v_mfma_f32_16x16x32_bf16 v[28:31], v[96:99], v[208:211], v[28:31]
  v_mfma_f32_16x16x32_bf16 v[32:35], v[96:99], v[212:215], v[32:35]
  s_add_u32 s77, s73, s78
  buffer_load_dwordx4 v[196:199], v4, s[32:35], s77 offen sc1
  v_mfma_f32_16x16x32_bf16 v[36:39], v[96:99], v[216:219], v[36:39]
  v_mfma_f32_16x16x32_bf16 v[40:43], v[96:99], v[220:223], v[40:43]
  ds_read_b128 v[96:99], v11 offset:6144
  v_mfma_f32_16x16x32_bf16 v[44:47], v[100:103], v[208:211], v[44:47]
  v_mfma_f32_16x16x32_bf16 v[48:51], v[100:103], v[212:215], v[48:51]
  s_add_u32 s77, s74, s78
  buffer_load_dwordx4 v[200:203], v4, s[32:35], s77 offen sc1
  v_mfma_f32_16x16x32_bf16 v[52:55], v[100:103], v[216:219], v[52:55]
  v_mfma_f32_16x16x32_bf16 v[56:59], v[100:103], v[220:223], v[56:59]
  ds_read_b128 v[100:103], v11 offset:10240
  v_mfma_f32_16x16x32_bf16 v[60:63], v[104:107], v[208:211], v[60:63]
  v_mfma_f32_16x16x32_bf16 v[64:67], v[104:107], v[212:215], v[64:67]
  s_add_u32 s77, s75, s78
  buffer_load_dwordx4 v[204:207], v4, s[32:35], s77 offen sc1
  v_mfma_f32_16x16x32_bf16 v[68:71], v[104:107], v[216:219], v[68:71]
  v_mfma_f32_16x16x32_bf16 v[72:75], v[104:107], v[220:223], v[72:75]
  ds_read_b128 v[104:107], v11 offset:14336
  v_mfma_f32_16x16x32_bf16 v[76:79], v[108:111], v[208:211], v[76:79]
  v_mfma_f32_16x16x32_bf16 v[80:83], v[108:111], v[212:215], v[80:83]
  v_mfma_f32_16x16x32_bf16 v[84:87], v[108:111], v[216:219], v[84:87]
  v_mfma_f32_16x16x32_bf16 v[88:91], v[108:111], v[220:223], v[88:91]
  ds_read_b128 v[108:111], v11 offset:18432
  s_waitcnt vmcnt(8)
  v_mfma_f32_16x16x32_bf16 v[12:15], v[112:115], v[224:227], v[12:15]
  v_mfma_f32_16x16x32_bf16 v[16:19], v[112:115], v[228:231], v[16:19]
  s_add_u32 s77, s72, s79
  buffer_load_dwordx4 v[208:211], v4, s[32:35], s77 offen sc1
  v_mfma_f32_16x16x32_bf16 v[20:23], v[112:115], v[232:235], v[20:23]
  v_mfma_f32_16x16x32_bf16 v[24:27], v[112:115], v[236:239], v[24:27]
  ds_read_b128 v[112:115], v11 offset:3072
  v_mfma_f32_16x16x32_bf16 v[28:31], v[116:119], v[224:227], v[28:31]
  v_mfma_f32_16x16x32_bf16 v[32:35], v[116:119], v[228:231], v[32:35]
  s_add_u32 s77, s73, s79
  buffer_load_dwordx4 v[212:215], v4, s[32:35], s77 offen sc1
  v_mfma_f32_16x16x32_bf16 v[36:39], v[116:119], v[232:235], v[36:39]
  v_mfma_f32_16x16x32_bf16 v[40:43], v[116:119], v[236:239], v[40:43]
  ds_read_b128 v[116:119], v11 offset:7168
  v_mfma_f32_16x16x32_bf16 v[44:47], v[120:123], v[224:227], v[44:47]
  v_mfma_f32_16x16x32_bf16 v[48:51], v[120:123], v[228:231], v[48:51]
  s_add_u32 s77, s74, s79
  buffer_load_dwordx4 v[216:219], v4, s[32:35], s77 offen sc1
  v_mfma_f32_16x16x32_bf16 v[52:55], v[120:123], v[232:235], v[52:55]
  v_mfma_f32_16x16x32_bf16 v[56:59], v[120:123], v[236:239], v[56:59]
  ds_read_b128 v[120:123], v11 offset:11264
  v_mfma_f32_16x16x32_bf16 v[60:63], v[124:127], v[224:227], v[60:63]
  v_mfma_f32_16x16x32_bf16 v[64:67], v[124:127], v[228:231], v[64:67]
  s_add_u32 s77, s75, s79
  buffer_load_dwordx4 v[220:223], v4, s[32:35], s77 offen sc1
  v_mfma_f32_16x16x32_bf16 v[68:71], v[124:127], v[232:235], v[68:71]
  v_mfma_f32_16x16x32_bf16 v[72:75], v[124:127], v[236:239], v[72:75]
  ds_read_b128 v[124:127], v11 offset:15360
  v_mfma_f32_16x16x32_bf16 v[76:79], v[128:131], v[224:227], v[76:79]
  v_mfma_f32_16x16x32_bf16 v[80:83], v[128:131], v[228:231], v[80:83]
  v_mfma_f32_16x16x32_bf16 v[84:87], v[128:131], v[232:235], v[84:87]
  v_mfma_f32_16x16x32_bf16 v[88:91], v[128:131], v[236:239], v[88:91]
  ds_read_b128 v[128:131], v11 offset:19456
  s_waitcnt vmcnt(8)
  v_mfma_f32_16x16x32_bf16 v[12:15], v[132:135], v[240:243], v[12:15]
  v_mfma_f32_16x16x32_bf16 v[16:19], v[132:135], v[244:247], v[16:19]
  s_add_u32 s77, s72, s80
  buffer_load_dwordx4 v[224:227], v4, s[32:35], s77 offen sc1
  v_mfma_f32_16x16x32_bf16 v[20:23], v[132:135], v[248:251], v[20:23]
  v_mfma_f32_16x16x32_bf16 v[24:27], v[132:135], v[252:255], v[24:27]
  v_mfma_f32_16x16x32_bf16 v[28:31], v[136:139], v[240:243], v[28:31]
  v_mfma_f32_16x16x32_bf16 v[32:35], v[136:139], v[244:247], v[32:35]
  s_add_u32 s77, s73, s80
  buffer_load_dwordx4 v[228:231], v4, s[32:35], s77 offen sc1
  v_mfma_f32_16x16x32_bf16 v[36:39], v[136:139], v[248:251], v[36:39]
  v_mfma_f32_16x16x32_bf16 v[40:43], v[136:139], v[252:255], v[40:43]
  v_mfma_f32_16x16x32_bf16 v[44:47], v[140:143], v[240:243], v[44:47]
  v_mfma_f32_16x16x32_bf16 v[48:51], v[140:143], v[244:247], v[48:51]
  s_add_u32 s77, s74, s80
  buffer_load_dwordx4 v[232:235], v4, s[32:35], s77 offen sc1
  v_mfma_f32_16x16x32_bf16 v[52:55], v[140:143], v[248:251], v[52:55]
  v_mfma_f32_16x16x32_bf16 v[56:59], v[140:143], v[252:255], v[56:59]
  v_mfma_f32_16x16x32_bf16 v[60:63], v[144:147], v[240:243], v[60:63]
  v_mfma_f32_16x16x32_bf16 v[64:67], v[144:147], v[244:247], v[64:67]
  s_add_u32 s77, s75, s80
  buffer_load_dwordx4 v[236:239], v4, s[32:35], s77 offen sc1
  v_mfma_f32_16x16x32_bf16 v[68:71], v[144:147], v[248:251], v[68:71]
  v_mfma_f32_16x16x32_bf16 v[72:75], v[144:147], v[252:255], v[72:75]
  v_mfma_f32_16x16x32_bf16 v[76:79], v[148:151], v[240:243], v[76:79]
  v_mfma_f32_16x16x32_bf16 v[80:83], v[148:151], v[244:247], v[80:83]
  v_mfma_f32_16x16x32_bf16 v[84:87], v[148:151], v[248:251], v[84:87]
  v_mfma_f32_16x16x32_bf16 v[88:91], v[148:151], v[252:255], v[88:91]
  s_mov_b32 exec_lo, 0xfffff
  s_mov_b32 exec_hi, 0
  buffer_load_dword v10, v9, s[32:35], 0 offen sc1
  s_mov_b64 exec, -1
  s_waitcnt vmcnt(9)
  s_waitcnt lgkmcnt(15)
  v_mfma_f32_16x16x32_bf16 v[12:15], v[152:155], v[192:195], v[12:15]
  v_mfma_f32_16x16x32_bf16 v[16:19], v[152:155], v[196:199], v[16:19]
  s_add_u32 s77, s72, s81
  buffer_load_dwordx4 v[240:243], v4, s[32:35], s77 offen sc1
  v_mfma_f32_16x16x32_bf16 v[20:23], v[152:155], v[200:203], v[20:23]
  v_mfma_f32_16x16x32_bf16 v[24:27], v[152:155], v[204:207], v[24:27]
  v_mfma_f32_16x16x32_bf16 v[28:31], v[156:159], v[192:195], v[28:31]
  v_mfma_f32_16x16x32_bf16 v[32:35], v[156:159], v[196:199], v[32:35]
  s_add_u32 s77, s73, s81
  buffer_load_dwordx4 v[244:247], v4, s[32:35], s77 offen sc1
  v_mfma_f32_16x16x32_bf16 v[36:39], v[156:159], v[200:203], v[36:39]
  v_mfma_f32_16x16x32_bf16 v[40:43], v[156:159], v[204:207], v[40:43]
  v_mfma_f32_16x16x32_bf16 v[44:47], v[160:163], v[192:195], v[44:47]
  v_mfma_f32_16x16x32_bf16 v[48:51], v[160:163], v[196:199], v[48:51]
  s_add_u32 s77, s74, s81
  buffer_load_dwordx4 v[248:251], v4, s[32:35], s77 offen sc1
  v_mfma_f32_16x16x32_bf16 v[52:55], v[160:163], v[200:203], v[52:55]
  v_mfma_f32_16x16x32_bf16 v[56:59], v[160:163], v[204:207], v[56:59]
  v_mfma_f32_16x16x32_bf16 v[60:63], v[164:167], v[192:195], v[60:63]
  v_mfma_f32_16x16x32_bf16 v[64:67], v[164:167], v[196:199], v[64:67]
  s_add_u32 s77, s75, s81
  buffer_load_dwordx4 v[252:255], v4, s[32:35], s77 offen sc1
  v_mfma_f32_16x16x32_bf16 v[68:71], v[164:167], v[200:203], v[68:71]
  v_mfma_f32_16x16x32_bf16 v[72:75], v[164:167], v[204:207], v[72:75]
  v_mfma_f32_16x16x32_bf16 v[76:79], v[168:171], v[192:195], v[76:79]
  v_mfma_f32_16x16x32_bf16 v[80:83], v[168:171], v[196:199], v[80:83]
  v_mfma_f32_16x16x32_bf16 v[84:87], v[168:171], v[200:203], v[84:87]
  v_mfma_f32_16x16x32_bf16 v[88:91], v[168:171], v[204:207], v[88:91]
  buffer_load_dwordx2 v[132:133], v6, s[36:39], 0 offen offset:0
  buffer_load_dwordx2 v[134:135], v6, s[36:39], 0 offen offset:32
  buffer_load_dwordx2 v[136:137], v6, s[36:39], 0 offen offset:64
  buffer_load_dwordx2 v[138:139], v6, s[36:39], 0 offen offset:96
  buffer_load_dwordx2 v[140:141], v6, s[36:39], 0 offen offset:128
  s_waitcnt vmcnt(14)
  s_waitcnt lgkmcnt(10)
  v_mfma_f32_16x16x32_bf16 v[12:15], v[172:175], v[208:211], v[12:15]
  v_mfma_f32_16x16x32_bf16 v[16:19], v[172:175], v[212:215], v[16:19]
  v_mfma_f32_16x16x32_bf16 v[20:23], v[172:175], v[216:219], v[20:23]
  v_mfma_f32_16x16x32_bf16 v[24:27], v[172:175], v[220:223], v[24:27]
  v_mfma_f32_16x16x32_bf16 v[28:31], v[176:179], v[208:211], v[28:31]
  v_mfma_f32_16x16x32_bf16 v[32:35], v[176:179], v[212:215], v[32:35]
  v_mfma_f32_16x16x32_bf16 v[36:39], v[176:179], v[216:219], v[36:39]
  v_mfma_f32_16x16x32_bf16 v[40:43], v[176:179], v[220:223], v[40:43]
  v_mfma_f32_16x16x32_bf16 v[44:47], v[180:183], v[208:211], v[44:47]
  v_mfma_f32_16x16x32_bf16 v[48:51], v[180:183], v[212:215], v[48:51]
  v_mfma_f32_16x16x32_bf16 v[52:55], v[180:183], v[216:219], v[52:55]
  v_mfma_f32_16x16x32_bf16 v[56:59], v[180:183], v[220:223], v[56:59]
  v_mfma_f32_16x16x32_bf16 v[60:63], v[184:187], v[208:211], v[60:63]
  v_mfma_f32_16x16x32_bf16 v[64:67], v[184:187], v[212:215], v[64:67]
  v_mfma_f32_16x16x32_bf16 v[68:71], v[184:187], v[216:219], v[68:71]
  v_mfma_f32_16x16x32_bf16 v[72:75], v[184:187], v[220:223], v[72:75]
  v_mfma_f32_16x16x32_bf16 v[76:79], v[188:191], v[208:211], v[76:79]
  v_mfma_f32_16x16x32_bf16 v[80:83], v[188:191], v[212:215], v[80:83]
  v_mfma_f32_16x16x32_bf16 v[84:87], v[188:191], v[216:219], v[84:87]
  v_mfma_f32_16x16x32_bf16 v[88:91], v[188:191], v[220:223], v[88:91]
  s_waitcnt vmcnt(9)
  s_mov_b32 exec_lo, 0xfffff
  s_mov_b32 exec_hi, 0
  v_cmp_ne_u32 vcc, s40, v10
  s_nop 3
  s_mov_b64 s[44:45], vcc
  s_cmp_lg_u64 s[44:45], 0
  s_mov_b64 exec, -1
  s_cbranch_scc0 Lok_53
  s_mov_b32 exec_lo, 0xfffff
  s_mov_b32 exec_hi, 0x0
  s_mov_b32 s41, 0x40000
  s_branch Lpf_56
Lpoll_54:
  s_sleep 4
Lpf_56:
  buffer_load_dword v10, v9, s[32:35], 0 offen sc1
  s_sub_u32 s41, s41, 1
  s_cbranch_scc1 Lpout_55
  s_waitcnt vmcnt(0)
  v_cmp_ne_u32 vcc, s40, v10
  s_nop 3
  s_mov_b64 s[44:45], vcc
  s_cmp_lg_u64 s[44:45], 0
  s_cbranch_scc1 Lpoll_54
Lpout_55:
  s_waitcnt vmcnt(0)
  s_mov_b64 exec, -1
Lok_53:
  s_mov_b32 s61, 0
  buffer_load_ushort v142, v7, s[32:35], s61 offen sc1
  s_mov_b32 s61, 4096
  buffer_load_ushort v143, v7, s[32:35], s61 offen sc1
  s_mov_b32 s61, 8192
  buffer_load_ushort v144, v7, s[32:35], s61 offen sc1
  s_mov_b32 s61, 12288
  buffer_load_ushort v145, v7, s[32:35], s61 offen sc1
  s_mov_b32 s61, 65536
  buffer_load_ushort v146, v7, s[32:35], s61 offen sc1
  s_mov_b32 s61, 69632
  buffer_load_ushort v147, v7, s[32:35], s61 offen sc1
  s_mov_b32 s61, 73728
  buffer_load_ushort v148, v7, s[32:35], s61 offen sc1
  s_mov_b32 s61, 77824
  buffer_load_ushort v149, v7, s[32:35], s61 offen sc1
  s_mov_b32 s61, 131072
  buffer_load_ushort v150, v7, s[32:35], s61 offen sc1
  s_mov_b32 s61, 135168
  buffer_load_ushort v151, v7, s[32:35], s61 offen sc1
  s_mov_b32 s61, 139264
  buffer_load_ushort v152, v7, s[32:35], s61 offen sc1
  s_mov_b32 s61, 143360
  buffer_load_ushort v153, v7, s[32:35], s61 offen sc1
  s_mov_b32 s61, 196608
  buffer_load_ushort v154, v7, s[32:35], s61 offen sc1
  s_mov_b32 s61, 200704
  buffer_load_ushort v155, v7, s[32:35], s61 offen sc1
  s_mov_b32 s61, 204800
  buffer_load_ushort v156, v7, s[32:35], s61 offen sc1
  s_mov_b32 s61, 208896
  buffer_load_ushort v157, v7, s[32:35], s61 offen sc1
  s_mov_b32 s61, 262144
  buffer_load_ushort v158, v7, s[32:35], s61 offen sc1
  s_mov_b32 s61, 266240
  buffer_load_ushort v159, v7, s[32:35], s61 offen sc1
  s_mov_b32 s61, 270336
  buffer_load_ushort v160, v7, s[32:35], s61 offen sc1
  s_mov_b32 s61, 274432
  buffer_load_ushort v161, v7, s[32:35], s61 offen sc1
  s_waitcnt lgkmcnt(5)
  v_mfma_f32_16x16x32_bf16 v[12:15], v[92:95], v[224:227], v[12:15]
  v_mfma_f32_16x16x32_bf16 v[16:19], v[92:95], v[228:231], v[16:19]
  v_mfma_f32_16x16x32_bf16 v[20:23], v[92:95], v[232:235], v[20:23]
  v_mfma_f32_16x16x32_bf16 v[24:27], v[92:95], v[236:239], v[24:27]
  v_mfma_f32_16x16x32_bf16 v[28:31], v[96:99], v[224:227], v[28:31]
  v_mfma_f32_16x16x32_bf16 v[32:35], v[96:99], v[228:231], v[32:35]
  v_mfma_f32_16x16x32_bf16 v[36:39], v[96:99], v[232:235], v[36:39]
  v_mfma_f32_16x16x32_bf16 v[40:43], v[96:99], v[236:239], v[40:43]
  v_mfma_f32_16x16x32_bf16 v[44:47], v[100:103], v[224:227], v[44:47]
  v_mfma_f32_16x16x32_bf16 v[48:51], v[100:103], v[228:231], v[48:51]
  v_mfma_f32_16x16x32_bf16 v[52:55], v[100:103], v[232:235], v[52:55]
  v_mfma_f32_16x16x32_bf16 v[56:59], v[100:103], v[236:239], v[56:59]
  v_mfma_f32_16x16x32_bf16 v[60:63], v[104:107], v[224:227], v[60:63]
  v_mfma_f32_16x16x32_bf16 v[64:67], v[104:107], v[228:231], v[64:67]
  v_mfma_f32_16x16x32_bf16 v[68:71], v[104:107], v[232:235], v[68:71]
  v_mfma_f32_16x16x32_bf16 v[72:75], v[104:107], v[236:239], v[72:75]
  v_mfma_f32_16x16x32_bf16 v[76:79], v[108:111], v[224:227], v[76:79]
  v_mfma_f32_16x16x32_bf16 v[80:83], v[108:111], v[228:231], v[80:83]
  v_mfma_f32_16x16x32_bf16 v[84:87], v[108:111], v[232:235], v[84:87]
  v_mfma_f32_16x16x32_bf16 v[88:91], v[108:111], v[236:239], v[88:91]
  s_waitcnt vmcnt(25)
  s_waitcnt lgkmcnt(0)
  v_mfma_f32_16x16x32_bf16 v[16:19], v[112:115], v[244:247], v[16:19]
  v_mfma_f32_16x16x32_bf16 v[20:23], v[112:115], v[248:251], v[20:23]
  v_mfma_f32_16x16x32_bf16 v[24:27], v[112:115], v[252:255], v[24:27]
  v_mfma_f32_16x16x32_bf16 v[12:15], v[112:115], v[240:243], v[12:15]
  v_mfma_f32_16x16x32_bf16 v[32:35], v[116:119], v[244:247], v[32:35]
  v_mfma_f32_16x16x32_bf16 v[36:39], v[116:119], v[248:251], v[36:39]
  v_mfma_f32_16x16x32_bf16 v[40:43], v[116:119], v[252:255], v[40:43]
  v_mfma_f32_16x16x32_bf16 v[28:31], v[116:119], v[240:243], v[28:31]
  v_mfma_f32_16x16x32_bf16 v[48:51], v[120:123], v[244:247], v[48:51]
  v_mfma_f32_16x16x32_bf16 v[52:55], v[120:123], v[248:251], v[52:55]
  v_mfma_f32_16x16x32_bf16 v[56:59], v[120:123], v[252:255], v[56:59]
  v_mfma_f32_16x16x32_bf16 v[44:47], v[120:123], v[240:243], v[44:47]
  v_mfma_f32_16x16x32_bf16 v[64:67], v[124:127], v[244:247], v[64:67]
  v_mfma_f32_16x16x32_bf16 v[68:71], v[124:127], v[248:251], v[68:71]
  v_mfma_f32_16x16x32_bf16 v[72:75], v[124:127], v[252:255], v[72:75]
  v_mfma_f32_16x16x32_bf16 v[60:63], v[124:127], v[240:243], v[60:63]
  v_mfma_f32_16x16x32_bf16 v[80:83], v[128:131], v[244:247], v[80:83]
  v_mfma_f32_16x16x32_bf16 v[84:87], v[128:131], v[248:251], v[84:87]
  v_mfma_f32_16x16x32_bf16 v[88:91], v[128:131], v[252:255], v[88:91]
  v_mfma_f32_16x16x32_bf16 v[76:79], v[128:131], v[240:243], v[76:79]
  s_barrier
  s_add_u32 s61, s56, 1
  s_and_b32 s61, s61, 3
  s_mul_i32 s61, s61, 15360
  s_add_u32 s61, s61, 0
  v_add_u32 v5, s61, v4
  ds_write_b128 v5, v[16:19] offset:0
  ds_write_b128 v5, v[32:35] offset:1024
  ds_write_b128 v5, v[48:51] offset:2048
  ds_write_b128 v5, v[64:67] offset:3072
  ds_write_b128 v5, v[80:83] offset:4096
  s_add_u32 s61, s56, 2
  s_and_b32 s61, s61, 3
  s_mul_i32 s61, s61, 15360
  s_add_u32 s61, s61, 5120
  v_add_u32 v5, s61, v4
  ds_write_b128 v5, v[20:23] offset:0
  ds_write_b128 v5, v[36:39] offset:1024
  ds_write_b128 v5, v[52:55] offset:2048
  ds_write_b128 v5, v[68:71] offset:3072
  ds_write_b128 v5, v[84:87] offset:4096
  s_add_u32 s61, s56, 3
  s_and_b32 s61, s61, 3
  s_mul_i32 s61, s61, 15360
  s_add_u32 s61, s61, 10240
  v_add_u32 v5, s61, v4
  ds_write_b128 v5, v[24:27] offset:0
  ds_write_b128 v5, v[40:43] offset:1024
  ds_write_b128 v5, v[56:59] offset:2048
  ds_write_b128 v5, v[72:75] offset:3072
  ds_write_b128 v5, v[88:91] offset:4096
  s_waitcnt lgkmcnt(0)
  s_barrier
  s_mul_i32 s61, s56, 15360
  v_add_u32 v5, s61, v4
  ds_read_b128 v[192:195], v5 offset:0
  ds_read_b128 v[196:199], v5 offset:1024
  ds_read_b128 v[200:203], v5 offset:2048
  ds_read_b128 v[204:207], v5 offset:3072
  ds_read_b128 v[208:211], v5 offset:4096
  ds_read_b128 v[212:215], v5 offset:5120
  ds_read_b128 v[216:219], v5 offset:6144
  ds_read_b128 v[220:223], v5 offset:7168
  ds_read_b128 v[224:227], v5 offset:8192
  ds_read_b128 v[228:231], v5 offset:9216
  ds_read_b128 v[232:235], v5 offset:10240
  ds_read_b128 v[236:239], v5 offset:11264
  ds_read_b128 v[240:243], v5 offset:12288
  ds_read_b128 v[244:247], v5 offset:13312
  ds_read_b128 v[248:251], v5 offset:14336
  s_mov_b32 s52, s26
  s_and_b32 s53, s27, 0xffff
  s_mov_b32 s54, 0x280000
  s_mov_b32 s55, 0x20000
  s_waitcnt lgkmcnt(10)
  v_add_f32 v12, v12, v192
  v_add_f32 v13, v13, v193
  v_add_f32 v14, v14, v194
  v_add_f32 v15, v15, v195
  v_add_f32 v28, v28, v196
  v_add_f32 v29, v29, v197
  v_add_f32 v30, v30, v198
  v_add_f32 v31, v31, v199
  v_add_f32 v44, v44, v200
  v_add_f32 v45, v45, v201
  v_add_f32 v46, v46, v202
  v_add_f32 v47, v47, v203
  v_add_f32 v60, v60, v204
  v_add_f32 v61, v61, v205
  v_add_f32 v62, v62, v206
  v_add_f32 v63, v63, v207
  v_add_f32 v76, v76, v208
  v_add_f32 v77, v77, v209
  v_add_f32 v78, v78, v210
  v_add_f32 v79, v79, v211
  s_waitcnt lgkmcnt(5)
  v_add_f32 v12, v12, v212
  v_add_f32 v13, v13, v213
  v_add_f32 v14, v14, v214
  v_add_f32 v15, v15, v215
  v_add_f32 v28, v28, v216
  v_add_f32 v29, v29, v217
  v_add_f32 v30, v30, v218
  v_add_f32 v31, v31, v219
  v_add_f32 v44, v44, v220
  v_add_f32 v45, v45, v221
  v_add_f32 v46, v46, v222
  v_add_f32 v47, v47, v223
  v_add_f32 v60, v60, v224
  v_add_f32 v61, v61, v225
  v_add_f32 v62, v62, v226
  v_add_f32 v63, v63, v227
  v_add_f32 v76, v76, v228
  v_add_f32 v77, v77, v229
  v_add_f32 v78, v78, v230
  v_add_f32 v79, v79, v231
  s_waitcnt lgkmcnt(0)
  v_add_f32 v12, v12, v232
  v_add_f32 v13, v13, v233
  v_add_f32 v14, v14, v234
  v_add_f32 v15, v15, v235
  v_add_f32 v28, v28, v236
  v_add_f32 v29, v29, v237
  v_add_f32 v30, v30, v238
  v_add_f32 v31, v31, v239
  v_add_f32 v44, v44, v240
  v_add_f32 v45, v45, v241
  v_add_f32 v46, v46, v242
  v_add_f32 v47, v47, v243
  v_add_f32 v60, v60, v244
  v_add_f32 v61, v61, v245
  v_add_f32 v62, v62, v246
  v_add_f32 v63, v63, v247
  v_add_f32 v76, v76, v248
  v_add_f32 v77, v77, v249
  v_add_f32 v78, v78, v250
  v_add_f32 v79, v79, v251
  s_waitcnt vmcnt(0)
  v_lshlrev_b32 v92, 16, v132
  v_and_b32 v93, 0xffff0000, v132
  v_lshlrev_b32 v94, 16, v133
  v_and_b32 v95, 0xffff0000, v133
  v_lshlrev_b32 v142, 16, v142
  v_lshlrev_b32 v143, 16, v143
  v_lshlrev_b32 v144, 16, v144
  v_lshlrev_b32 v145, 16, v145
  v_add_f32 v92, v92, v142
  v_add_f32 v93, v93, v143
  v_add_f32 v94, v94, v144
  v_add_f32 v95, v95, v145
  v_cvt_pk_bf16_f32 v96, v92, v93
  v_cvt_pk_bf16_f32 v97, v94, v95
  v_cvt_pk_bf16_f32 v98, v12, v13
  v_cvt_pk_bf16_f32 v99, v14, v15
  v_lshlrev_b32 v92, 16, v96
  v_and_b32 v93, 0xffff0000, v96
  v_lshlrev_b32 v94, 16, v98
  v_and_b32 v95, 0xffff0000, v98
  v_add_f32 v92, v92, v94
  v_add_f32 v93, v93, v95
  v_cvt_pk_bf16_f32 v100, v92, v93
  v_lshlrev_b32 v92, 16, v97
  v_and_b32 v93, 0xffff0000, v97
  v_lshlrev_b32 v94, 16, v99
  v_and_b32 v95, 0xffff0000, v99
  v_add_f32 v92, v92, v94
  v_add_f32 v93, v93, v95
  v_cvt_pk_bf16_f32 v101, v92, v93
  buffer_store_dwordx2 v[100:101], v6, s[52:55], 0 offen offset:0
  v_lshlrev_b32 v92, 16, v134
  v_and_b32 v93, 0xffff0000, v134
  v_lshlrev_b32 v94, 16, v135
  v_and_b32 v95, 0xffff0000, v135
  v_lshlrev_b32 v146, 16, v146
  v_lshlrev_b32 v147, 16, v147
  v_lshlrev_b32 v148, 16, v148
  v_lshlrev_b32 v149, 16, v149
  v_add_f32 v92, v92, v146
  v_add_f32 v93, v93, v147
  v_add_f32 v94, v94, v148
  v_add_f32 v95, v95, v149
  v_cvt_pk_bf16_f32 v96, v92, v93
  v_cvt_pk_bf16_f32 v97, v94, v95
  v_cvt_pk_bf16_f32 v98, v28, v29
  v_cvt_pk_bf16_f32 v99, v30, v31
  v_lshlrev_b32 v92, 16, v96
  v_and_b32 v93, 0xffff0000, v96
  v_lshlrev_b32 v94, 16, v98
  v_and_b32 v95, 0xffff0000, v98
  v_add_f32 v92, v92, v94
  v_add_f32 v93, v93, v95
  v_cvt_pk_bf16_f32 v102, v92, v93
  v_lshlrev_b32 v92, 16, v97
  v_and_b32 v93, 0xffff0000, v97
  v_lshlrev_b32 v94, 16, v99
  v_and_b32 v95, 0xffff0000, v99
  v_add_f32 v92, v92, v94
  v_add_f32 v93, v93, v95
  v_cvt_pk_bf16_f32 v103, v92, v93
  buffer_store_dwordx2 v[102:103], v6, s[52:55], 0 offen offset:32
  v_lshlrev_b32 v92, 16, v136
  v_and_b32 v93, 0xffff0000, v136
  v_lshlrev_b32 v94, 16, v137
  v_and_b32 v95, 0xffff0000, v137
  v_lshlrev_b32 v150, 16, v150
  v_lshlrev_b32 v151, 16, v151
  v_lshlrev_b32 v152, 16, v152
  v_lshlrev_b32 v153, 16, v153
  v_add_f32 v92, v92, v150
  v_add_f32 v93, v93, v151
  v_add_f32 v94, v94, v152
  v_add_f32 v95, v95, v153
  v_cvt_pk_bf16_f32 v96, v92, v93
  v_cvt_pk_bf16_f32 v97, v94, v95
  v_cvt_pk_bf16_f32 v98, v44, v45
  v_cvt_pk_bf16_f32 v99, v46, v47
  v_lshlrev_b32 v92, 16, v96
  v_and_b32 v93, 0xffff0000, v96
  v_lshlrev_b32 v94, 16, v98
  v_and_b32 v95, 0xffff0000, v98
  v_add_f32 v92, v92, v94
  v_add_f32 v93, v93, v95
  v_cvt_pk_bf16_f32 v100, v92, v93
  v_lshlrev_b32 v92, 16, v97
  v_and_b32 v93, 0xffff0000, v97
  v_lshlrev_b32 v94, 16, v99
  v_and_b32 v95, 0xffff0000, v99
  v_add_f32 v92, v92, v94
  v_add_f32 v93, v93, v95
  v_cvt_pk_bf16_f32 v101, v92, v93
  buffer_store_dwordx2 v[100:101], v6, s[52:55], 0 offen offset:64
  v_lshlrev_b32 v92, 16, v138
  v_and_b32 v93, 0xffff0000, v138
  v_lshlrev_b32 v94, 16, v139
  v_and_b32 v95, 0xffff0000, v139
  v_lshlrev_b32 v154, 16, v154
  v_lshlrev_b32 v155, 16, v155
  v_lshlrev_b32 v156, 16, v156
  v_lshlrev_b32 v157, 16, v157
  v_add_f32 v92, v92, v154
  v_add_f32 v93, v93, v155
  v_add_f32 v94, v94, v156
  v_add_f32 v95, v95, v157
  v_cvt_pk_bf16_f32 v96, v92, v93
  v_cvt_pk_bf16_f32 v97, v94, v95
  v_cvt_pk_bf16_f32 v98, v60, v61
  v_cvt_pk_bf16_f32 v99, v62, v63
  v_lshlrev_b32 v92, 16, v96
  v_and_b32 v93, 0xffff0000, v96
  v_lshlrev_b32 v94, 16, v98
  v_and_b32 v95, 0xffff0000, v98
  v_add_f32 v92, v92, v94
  v_add_f32 v93, v93, v95
  v_cvt_pk_bf16_f32 v102, v92, v93
  v_lshlrev_b32 v92, 16, v97
  v_and_b32 v93, 0xffff0000, v97
  v_lshlrev_b32 v94, 16, v99
  v_and_b32 v95, 0xffff0000, v99
  v_add_f32 v92, v92, v94
  v_add_f32 v93, v93, v95
  v_cvt_pk_bf16_f32 v103, v92, v93
  buffer_store_dwordx2 v[102:103], v6, s[52:55], 0 offen offset:96
  v_lshlrev_b32 v92, 16, v140
  v_and_b32 v93, 0xffff0000, v140
  v_lshlrev_b32 v94, 16, v141
  v_and_b32 v95, 0xffff0000, v141
  v_lshlrev_b32 v158, 16, v158
  v_lshlrev_b32 v159, 16, v159
  v_lshlrev_b32 v160, 16, v160
  v_lshlrev_b32 v161, 16, v161
  v_add_f32 v92, v92, v158
  v_add_f32 v93, v93, v159
  v_add_f32 v94, v94, v160
  v_add_f32 v95, v95, v161
  v_cvt_pk_bf16_f32 v96, v92, v93
  v_cvt_pk_bf16_f32 v97, v94, v95
  v_cvt_pk_bf16_f32 v98, v76, v77
  v_cvt_pk_bf16_f32 v99, v78, v79
  v_lshlrev_b32 v92, 16, v96
  v_and_b32 v93, 0xffff0000, v96
  v_lshlrev_b32 v94, 16, v98
  v_and_b32 v95, 0xffff0000, v98
  v_add_f32 v92, v92, v94
  v_add_f32 v93, v93, v95
  v_cvt_pk_bf16_f32 v100, v92, v93
  v_lshlrev_b32 v92, 16, v97
  v_and_b32 v93, 0xffff0000, v97
  v_lshlrev_b32 v94, 16, v99
  v_and_b32 v95, 0xffff0000, v99
  v_add_f32 v92, v92, v94
  v_add_f32 v93, v93, v95
  v_cvt_pk_bf16_f32 v101, v92, v93
  buffer_store_dwordx2 v[100:101], v6, s[52:55], 0 offen offset:128
  s_cmp_lg_u32 s2, 0
  s_cbranch_scc1 Lnn_57
  s_cmp_lg_u32 s56, 0
  s_cbranch_scc1 Lnn_57
  v_add_u32 v100, 0, v1
  v_lshlrev_b32 v100, 8, v100
  v_add_u32 v100, 14811136, v100
  v_add_u32 v101, 64, v1
  v_lshlrev_b32 v101, 8, v101
  v_add_u32 v101, 14811136, v101
  v_add_u32 v102, 128, v1
  v_lshlrev_b32 v102, 8, v102
  v_add_u32 v102, 14811136, v102
  v_add_u32 v103, 192, v1
  v_lshlrev_b32 v103, 8, v103
  v_add_u32 v103, 14811136, v103
  v_add_u32 v104, 0, v1
  v_min_u32 v104, 159, v104
  v_lshlrev_b32 v104, 6, v104
  v_add_u32 v104, 14745600, v104
  v_add_u32 v105, 64, v1
  v_min_u32 v105, 159, v105
  v_lshlrev_b32 v105, 6, v105
  v_add_u32 v105, 14745600, v105
  v_add_u32 v106, 128, v1
  v_min_u32 v106, 159, v106
  v_lshlrev_b32 v106, 6, v106
  v_add_u32 v106, 14745600, v106
  s_mov_b32 s41, 0x40000
  s_branch Lpf_60
Lpoll_58:
  s_sleep 4
Lpf_60:
  buffer_load_dword v108, v100, s[32:35], 0 offen sc1
  buffer_load_dword v109, v101, s[32:35], 0 offen sc1
  buffer_load_dword v110, v102, s[32:35], 0 offen sc1
  buffer_load_dword v111, v103, s[32:35], 0 offen sc1
  buffer_load_dword v112, v104, s[32:35], 0 offen sc1
  buffer_load_dword v113, v105, s[32:35], 0 offen sc1
  buffer_load_dword v114, v106, s[32:35], 0 offen sc1
  s_sub_u32 s41, s41, 1
  s_cbranch_scc1 Lpout_59
  s_waitcnt vmcnt(0)
  v_cmp_ne_u32 vcc, s40, v108
  s_nop 3
  s_mov_b64 s[44:45], vcc
  v_cmp_ne_u32 vcc, s40, v109
  s_nop 3
  s_or_b64 s[44:45], s[44:45], vcc
  v_cmp_ne_u32 vcc, s40, v110
  s_nop 3
  s_or_b64 s[44:45], s[44:45], vcc
  v_cmp_ne_u32 vcc, s40, v111
  s_nop 3
  s_or_b64 s[44:45], s[44:45], vcc
  v_cmp_ne_u32 vcc, s40, v112
  s_nop 3
  s_or_b64 s[44:45], s[44:45], vcc
  v_cmp_ne_u32 vcc, s40, v113
  s_nop 3
  s_or_b64 s[44:45], s[44:45], vcc
  v_cmp_ne_u32 vcc, s40, v114
  s_nop 3
  s_or_b64 s[44:45], s[44:45], vcc
  s_cmp_lg_u64 s[44:45], 0
  s_cbranch_scc1 Lpoll_58
Lpout_59:
  s_waitcnt vmcnt(0)
  s_mov_b32 s61, 14286848
  v_cmp_eq_u32 vcc, 0, v0
  s_nop 3
  s_and_saveexec_b64 s[42:43], vcc
  s_cbranch_execz Lfs_61
  v_mov_b32 v2, 0
  v_mov_b32 v3, s40
  buffer_store_dword v3, v2, s[32:35], s61 offen sc1
Lfs_61:
  s_mov_b64 exec, s[42:43]
Lnn_57:
  s_endpgm
Lnotgemm:
  s_setprio 3
  s_sub_u32 s46, s2, 256
  v_and_b32 v1, 63, v0
  v_lshrrev_b32 v2, 6, v0
  s_nop 0
  v_readfirstlane_b32 s64, v2
  s_lshl_b32 s65, s46, 2
  s_nop 2
  s_add_u32 s65, s65, s64
  s_waitcnt lgkmcnt(0)
  s_mov_b32 s32, s30
  s_and_b32 s33, s31, 0xffff
  s_mov_b32 s34, 0x1000000
  s_mov_b32 s35, 0x20000
  s_mov_b32 s36, s4
  s_and_b32 s37, s5, 0xffff
  s_mov_b32 s38, 0x280000
  s_mov_b32 s39, 0x20000
  s_mov_b32 s48, s6
  s_and_b32 s49, s7, 0xffff
  s_mov_b32 s50, 0x3c000
  s_mov_b32 s51, 0x20000
  s_mov_b32 s52, s8
  s_and_b32 s53, s9, 0xffff
  s_mov_b32 s54, 0x3c000
  s_mov_b32 s55, 0x20000
  s_mov_b32 s56, s10
  s_and_b32 s57, s11, 0xffff
  s_mov_b32 s58, 0x3c000
  s_mov_b32 s59, 0x20000
  s_mov_b32 s60, s12
  s_and_b32 s61, s13, 0xffff
  s_mov_b32 s62, 0x3c000
  s_mov_b32 s63, 0x20000
  s_lshr_b32 s66, s65, 1
  s_lshl_b32 s66, s66, 2
  s_load_dword s68, s[14:15], s66
  s_load_dword s69, s[16:17], s66
  s_mul_i32 s72, s65, 384
  v_lshlrev_b32 v238, 1, v1
  buffer_load_ushort v240, v238, s[48:51], s72 offen offset:0
  buffer_load_ushort v241, v238, s[52:55], s72 offen offset:0
  buffer_load_ushort v242, v238, s[56:59], s72 offen offset:0
  buffer_load_ushort v243, v238, s[60:63], s72 offen offset:0
  buffer_load_ushort v244, v238, s[48:51], s72 offen offset:128
  buffer_load_ushort v245, v238, s[52:55], s72 offen offset:128
  buffer_load_ushort v246, v238, s[56:59], s72 offen offset:128
  buffer_load_ushort v247, v238, s[60:63], s72 offen offset:128
  buffer_load_ushort v248, v238, s[48:51], s72 offen offset:256
  buffer_load_ushort v249, v238, s[52:55], s72 offen offset:256
  buffer_load_ushort v250, v238, s[56:59], s72 offen offset:256
  buffer_load_ushort v251, v238, s[60:63], s72 offen offset:256
  v_mov_b32 v254, 14286848
  buffer_load_dword v254, v254, s[32:35], 0 offen sc1
  s_setprio 2
  s_mul_i32 s70, s64, 18432
  v_mul_u32_u24 v5, 288, v1
  v_add_u32 v5, s70, v5
  v_bfe_u32 v2, v1, 2, 1
  v_lshlrev_b32 v2, 4, v2
  v_sub_u32 v8, v5, v2
  v_add_u32 v5, v5, v2
  v_bfe_u32 v2, v1, 4, 1
  v_lshlrev_b32 v2, 2, v2
  v_bfe_u32 v3, v1, 2, 2
  v_add_u32 v2, v2, v3
  v_mul_u32_u24 v6, 288, v2
  v_and_b32 v3, 1, v1
  v_lshl_add_u32 v6, v3, 3, v6
  v_bfe_u32 v3, v1, 1, 1
  v_bfe_u32 v2, v1, 4, 1
  v_xor_b32 v3, v3, v2
  v_lshl_add_u32 v6, v3, 4, v6
  v_add_u32 v6, s70, v6
  v_lshrrev_b32 v2, 5, v1
  v_mul_u32_u24 v3, 32, v2
  v_add_u32 v7, v6, v3
  v_add_u32 v7, 192, v7
  v_mul_u32_u24 v3, 96, v2
  v_add_u32 v6, v6, v3
  s_waitcnt lgkmcnt(0)
  s_and_b32 s66, s65, 1
  s_lshl_b32 s66, s66, 4
  s_lshr_b32 s68, s68, s66
  s_lshl_b32 s68, s68, 16
  s_lshr_b32 s69, s69, s66
  s_lshl_b32 s69, s69, 16
  v_mov_b32 v20, s68
  v_mul_f32 v20, 0x3fb8aa3b, v20
  v_exp_f32 v20, v20
  s_nop 0
  v_cvt_pk_bf16_f32 v20, v20, v20
  v_and_b32 v20, 0xffff0000, v20
  v_mov_b32 v24, 0
  v_mov_b32 v25, 0
  v_mov_b32 v26, 0
  v_mov_b32 v27, 0
  v_mov_b32 v28, 0
  v_mov_b32 v29, 0
  v_mov_b32 v30, 0
  v_mov_b32 v31, 0
  v_mov_b32 v32, 0
  v_mov_b32 v33, 0
  v_mov_b32 v34, 0
  v_mov_b32 v35, 0
  s_waitcnt vmcnt(1)
  s_mov_b32 s71, 3
Lkg_62:
  v_lshlrev_b32 v36, 16, v240
  v_lshlrev_b32 v37, 16, v241
  v_lshlrev_b32 v38, 16, v242
  v_lshlrev_b32 v39, 16, v243
  v_mov_b32 v240, v244
  v_mov_b32 v241, v245
  v_mov_b32 v242, v246
  v_mov_b32 v243, v247
  v_mov_b32 v244, v248
  v_mov_b32 v245, v249
  v_mov_b32 v246, v250
  v_mov_b32 v247, v251
  v_mul_f32 v40, 0x3fb8aa3b, v36
  v_exp_f32 v40, v40
  s_nop 0
  v_cvt_pk_bf16_f32 v40, v40, v40
  v_and_b32 v40, 0xffff0000, v40
  v_mul_f32 v40, v40, v20
  v_mul_f32 v40, 0xbfb8aa3b, v40
  v_mul_f32 v41, v37, v20
  v_mul_f32 v41, 0x3e22f983, v41
  v_exp_f32 v48, v40
  v_fract_f32 v49, v41
  v_cos_f32 v42, v49
  v_sin_f32 v43, v49
  v_mul_f32 v42, v48, v42
  v_mul_f32 v43, v48, v43
  v_mul_f32 v48, 0x41000000, v40
  v_exp_f32 v48, v48
  v_mul_f32 v49, 0x41000000, v41
  v_fract_f32 v49, v49
  v_cos_f32 v44, v49
  v_sin_f32 v45, v49
  v_mul_f32 v44, v48, v44
  v_mul_f32 v45, v48, v45
  v_add_f32 v48, v20, v20
  v_mul_f32 v52, v38, v48
  v_mul_f32 v53, v39, v48
  v_mov_b32 v136, 1.0
  v_mov_b32 v137, 0
  v_mov_b32 v138, v44
  v_mov_b32 v139, v45
  v_mul_f32 v140, v138, v44
  v_mul_f32 v141, v138, v45
  v_fma_f32 v140, -v139, v45, v140
  v_fma_f32 v141, v139, v44, v141
  v_mul_f32 v54, v52, v42
  v_mul_f32 v55, v52, v43
  v_fma_f32 v54, -v53, v43, v54
  v_fma_f32 v55, v53, v42, v55
  v_mul_f32 v142, v140, v44
  v_mul_f32 v143, v140, v45
  v_fma_f32 v142, -v141, v45, v142
  v_fma_f32 v143, v141, v44, v143
  v_mul_f32 v56, v54, v42
  v_mul_f32 v57, v54, v43
  v_fma_f32 v56, -v55, v43, v56
  v_fma_f32 v57, v55, v42, v57
  v_mul_f32 v144, v142, v44
  v_mul_f32 v145, v142, v45
  v_fma_f32 v144, -v143, v45, v144
  v_fma_f32 v145, v143, v44, v145
  v_mul_f32 v58, v56, v42
  v_mul_f32 v59, v56, v43
  v_fma_f32 v58, -v57, v43, v58
  v_fma_f32 v59, v57, v42, v59
  v_mul_f32 v146, v144, v44
  v_mul_f32 v147, v144, v45
  v_fma_f32 v146, -v145, v45, v146
  v_fma_f32 v147, v145, v44, v147
  v_mul_f32 v60, v58, v42
  v_mul_f32 v61, v58, v43
  v_fma_f32 v60, -v59, v43, v60
  v_fma_f32 v61, v59, v42, v61
  v_mul_f32 v148, v146, v44
  v_mul_f32 v149, v146, v45
  v_fma_f32 v148, -v147, v45, v148
  v_fma_f32 v149, v147, v44, v149
  v_mul_f32 v62, v60, v42
  v_mul_f32 v63, v60, v43
  v_fma_f32 v62, -v61, v43, v62
  v_fma_f32 v63, v61, v42, v63
  v_mul_f32 v150, v148, v44
  v_mul_f32 v151, v148, v45
  v_fma_f32 v150, -v149, v45, v150
  v_fma_f32 v151, v149, v44, v151
  v_mul_f32 v64, v62, v42
  v_mul_f32 v65, v62, v43
  v_fma_f32 v64, -v63, v43, v64
  v_fma_f32 v65, v63, v42, v65
  v_mul_f32 v152, v150, v44
  v_mul_f32 v153, v150, v45
  v_fma_f32 v152, -v151, v45, v152
  v_fma_f32 v153, v151, v44, v153
  v_mul_f32 v66, v64, v42
  v_mul_f32 v67, v64, v43
  v_fma_f32 v66, -v65, v43, v66
  v_fma_f32 v67, v65, v42, v67
  v_cvt_pk_bf16_f32 v172, v136, v138
  v_cvt_pk_bf16_f32 v173, v140, v142
  v_cvt_pk_bf16_f32 v174, v144, v146
  v_cvt_pk_bf16_f32 v175, v148, v150
  ds_write_b128 v5, v[172:175] offset:192
  v_cvt_pk_bf16_f32 v176, v137, v139
  v_cvt_pk_bf16_f32 v177, v141, v143
  v_cvt_pk_bf16_f32 v178, v145, v147
  v_cvt_pk_bf16_f32 v179, v149, v151
  ds_write_b128 v5, v[176:179] offset:224
  v_mul_f32 v154, v152, v44
  v_mul_f32 v155, v152, v45
  v_fma_f32 v154, -v153, v45, v154
  v_fma_f32 v155, v153, v44, v155
  v_mul_f32 v156, v154, v44
  v_mul_f32 v157, v154, v45
  v_fma_f32 v156, -v155, v45, v156
  v_fma_f32 v157, v155, v44, v157
  v_cvt_pk_bf16_f32 v180, v52, v54
  v_cvt_pk_bf16_f32 v181, v56, v58
  v_cvt_pk_bf16_f32 v182, v60, v62
  v_cvt_pk_bf16_f32 v183, v64, v66
  ds_write_b128 v5, v[180:183] offset:0
  v_cvt_pk_bf16_f32 v184, -v53, -v55
  v_cvt_pk_bf16_f32 v185, -v57, -v59
  v_cvt_pk_bf16_f32 v186, -v61, -v63
  v_cvt_pk_bf16_f32 v187, -v65, -v67
  ds_write_b128 v5, v[184:187] offset:96
  v_mul_f32 v158, v156, v44
  v_mul_f32 v159, v156, v45
  v_fma_f32 v158, -v157, v45, v158
  v_fma_f32 v159, v157, v44, v159
  v_mul_f32 v160, v158, v44
  v_mul_f32 v161, v158, v45
  v_fma_f32 v160, -v159, v45, v160
  v_fma_f32 v161, v159, v44, v161
  v_mul_f32 v162, v160, v44
  v_mul_f32 v163, v160, v45
  v_fma_f32 v162, -v161, v45, v162
  v_fma_f32 v163, v161, v44, v163
  v_mul_f32 v164, v162, v44
  v_mul_f32 v165, v162, v45
  v_fma_f32 v164, -v163, v45, v164
  v_fma_f32 v165, v163, v44, v165
  v_mul_f32 v166, v164, v44
  v_mul_f32 v167, v164, v45
  v_fma_f32 v166, -v165, v45, v166
  v_fma_f32 v167, v165, v44, v167
  v_mul_f32 v168, v166, v44
  v_mul_f32 v169, v166, v45
  v_fma_f32 v168, -v167, v45, v168
  v_fma_f32 v169, v167, v44, v169
  v_mul_f32 v68, v52, v168
  v_mul_f32 v69, v52, v169
  v_fma_f32 v68, -v53, v169, v68
  v_fma_f32 v69, v53, v168, v69
  v_mul_f32 v70, v54, v168
  v_mul_f32 v71, v54, v169
  v_fma_f32 v70, -v55, v169, v70
  v_fma_f32 v71, v55, v168, v71
  v_mul_f32 v72, v56, v168
  v_mul_f32 v73, v56, v169
  v_fma_f32 v72, -v57, v169, v72
  v_fma_f32 v73, v57, v168, v73
  v_mul_f32 v74, v58, v168
  v_mul_f32 v75, v58, v169
  v_fma_f32 v74, -v59, v169, v74
  v_fma_f32 v75, v59, v168, v75
  v_cvt_pk_bf16_f32 v188, v152, v154
  v_cvt_pk_bf16_f32 v189, v156, v158
  v_cvt_pk_bf16_f32 v190, v160, v162
  v_cvt_pk_bf16_f32 v191, v164, v166
  ds_write_b128 v8, v[188:191] offset:208
  v_mul_f32 v76, v60, v168
  v_mul_f32 v77, v60, v169
  v_fma_f32 v76, -v61, v169, v76
  v_fma_f32 v77, v61, v168, v77
  v_mul_f32 v78, v62, v168
  v_mul_f32 v79, v62, v169
  v_fma_f32 v78, -v63, v169, v78
  v_fma_f32 v79, v63, v168, v79
  v_mul_f32 v80, v64, v168
  v_mul_f32 v81, v64, v169
  v_fma_f32 v80, -v65, v169, v80
  v_fma_f32 v81, v65, v168, v81
  v_mul_f32 v82, v66, v168
  v_mul_f32 v83, v66, v169
  v_fma_f32 v82, -v67, v169, v82
  v_fma_f32 v83, v67, v168, v83
  v_cvt_pk_bf16_f32 v192, v153, v155
  v_cvt_pk_bf16_f32 v193, v157, v159
  v_cvt_pk_bf16_f32 v194, v161, v163
  v_cvt_pk_bf16_f32 v195, v165, v167
  ds_write_b128 v8, v[192:195] offset:240
  v_mul_f32 v84, v68, v168
  v_mul_f32 v85, v68, v169
  v_fma_f32 v84, -v69, v169, v84
  v_fma_f32 v85, v69, v168, v85
  v_mul_f32 v86, v72, v168
  v_mul_f32 v87, v72, v169
  v_fma_f32 v86, -v73, v169, v86
  v_fma_f32 v87, v73, v168, v87
  v_mul_f32 v88, v76, v168
  v_mul_f32 v89, v76, v169
  v_fma_f32 v88, -v77, v169, v88
  v_fma_f32 v89, v77, v168, v89
  v_mul_f32 v90, v80, v168
  v_mul_f32 v91, v80, v169
  v_fma_f32 v90, -v81, v169, v90
  v_fma_f32 v91, v81, v168, v91
  v_cvt_pk_bf16_f32 v196, v68, v70
  v_cvt_pk_bf16_f32 v197, v72, v74
  v_cvt_pk_bf16_f32 v198, v76, v78
  v_cvt_pk_bf16_f32 v199, v80, v82
  ds_write_b128 v8, v[196:199] offset:16
  v_cvt_pk_bf16_f32 v200, -v69, -v71
  v_cvt_pk_bf16_f32 v201, -v73, -v75
  v_cvt_pk_bf16_f32 v202, -v77, -v79
  v_cvt_pk_bf16_f32 v203, -v81, -v83
  ds_write_b128 v8, v[200:203] offset:112
  v_mul_f32 v92, v84, v168
  v_mul_f32 v93, v84, v169
  v_fma_f32 v92, -v85, v169, v92
  v_fma_f32 v93, v85, v168, v93
  v_mul_f32 v94, v86, v168
  v_mul_f32 v95, v86, v169
  v_fma_f32 v94, -v87, v169, v94
  v_fma_f32 v95, v87, v168, v95
  v_mul_f32 v96, v88, v168
  v_mul_f32 v97, v88, v169
  v_fma_f32 v96, -v89, v169, v96
  v_fma_f32 v97, v89, v168, v97
  v_mul_f32 v98, v90, v168
  v_mul_f32 v99, v90, v169
  v_fma_f32 v98, -v91, v169, v98
  v_fma_f32 v99, v91, v168, v99
  v_mul_f32 v100, v92, v168
  v_mul_f32 v101, v92, v169
  v_fma_f32 v100, -v93, v169, v100
  v_fma_f32 v101, v93, v168, v101
  v_mul_f32 v102, v96, v168
  v_mul_f32 v103, v96, v169
  v_fma_f32 v102, -v97, v169, v102
  v_fma_f32 v103, v97, v168, v103
  v_cvt_pk_bf16_f32 v172, v84, v86
  v_cvt_pk_bf16_f32 v173, v88, v90
  v_cvt_pk_bf16_f32 v174, v92, v94
  v_cvt_pk_bf16_f32 v175, v96, v98
  ds_write_b128 v5, v[172:175] offset:32
  v_cvt_pk_bf16_f32 v176, -v85, -v87
  v_cvt_pk_bf16_f32 v177, -v89, -v91
  v_cvt_pk_bf16_f32 v178, -v93, -v95
  v_cvt_pk_bf16_f32 v179, -v97, -v99
  ds_write_b128 v5, v[176:179] offset:128
  v_mul_f32 v104, v100, v168
  v_mul_f32 v105, v100, v169
  v_fma_f32 v104, -v101, v169, v104
  v_fma_f32 v105, v101, v168, v105
  v_mul_f32 v106, v102, v168
  v_mul_f32 v107, v102, v169
  v_fma_f32 v106, -v103, v169, v106
  v_fma_f32 v107, v103, v168, v107
  v_mul_f32 v108, v104, v168
  v_mul_f32 v109, v104, v169
  v_fma_f32 v108, -v105, v169, v108
  v_fma_f32 v109, v105, v168, v109
  v_mul_f32 v110, v106, v168
  v_mul_f32 v111, v106, v169
  v_fma_f32 v110, -v107, v169, v110
  v_fma_f32 v111, v107, v168, v111
  v_mul_f32 v112, v108, v168
  v_mul_f32 v113, v108, v169
  v_fma_f32 v112, -v109, v169, v112
  v_fma_f32 v113, v109, v168, v113
  v_mul_f32 v114, v110, v168
  v_mul_f32 v115, v110, v169
  v_fma_f32 v114, -v111, v169, v114
  v_fma_f32 v115, v111, v168, v115
  v_mul_f32 v116, v112, v168
  v_mul_f32 v117, v112, v169
  v_fma_f32 v116, -v113, v169, v116
  v_fma_f32 v117, v113, v168, v117
  v_mul_f32 v118, v116, v168
  v_mul_f32 v119, v116, v169
  v_fma_f32 v118, -v117, v169, v118
  v_fma_f32 v119, v117, v168, v119
  v_mul_f32 v120, v118, v168
  v_mul_f32 v121, v118, v169
  v_fma_f32 v120, -v119, v169, v120
  v_fma_f32 v121, v119, v168, v121
  v_cvt_pk_bf16_f32 v180, v100, v102
  v_cvt_pk_bf16_f32 v181, v104, v106
  v_cvt_pk_bf16_f32 v182, v108, v110
  v_cvt_pk_bf16_f32 v183, v112, v114
  ds_write_b128 v8, v[180:183] offset:48
  v_cvt_pk_bf16_f32 v184, -v101, -v103
  v_cvt_pk_bf16_f32 v185, -v105, -v107
  v_cvt_pk_bf16_f32 v186, -v109, -v111
  v_cvt_pk_bf16_f32 v187, -v113, -v115
  ds_write_b128 v8, v[184:187] offset:144
  v_mul_f32 v122, v120, v168
  v_mul_f32 v123, v120, v169
  v_fma_f32 v122, -v121, v169, v122
  v_fma_f32 v123, v121, v168, v123
  v_mul_f32 v124, v122, v168
  v_mul_f32 v125, v122, v169
  v_fma_f32 v124, -v123, v169, v124
  v_fma_f32 v125, v123, v168, v125
  v_mul_f32 v126, v124, v168
  v_mul_f32 v127, v124, v169
  v_fma_f32 v126, -v125, v169, v126
  v_fma_f32 v127, v125, v168, v127
  v_mul_f32 v128, v126, v168
  v_mul_f32 v129, v126, v169
  v_fma_f32 v128, -v127, v169, v128
  v_fma_f32 v129, v127, v168, v129
  v_mul_f32 v130, v128, v168
  v_mul_f32 v131, v128, v169
  v_fma_f32 v130, -v129, v169, v130
  v_fma_f32 v131, v129, v168, v131
  v_mul_f32 v132, v130, v168
  v_mul_f32 v133, v130, v169
  v_fma_f32 v132, -v131, v169, v132
  v_fma_f32 v133, v131, v168, v133
  v_mov_b32 v134, 0
  v_mov_b32 v135, 0
  v_cvt_pk_bf16_f32 v188, v116, v118
  v_cvt_pk_bf16_f32 v189, v120, v122
  v_cvt_pk_bf16_f32 v190, v124, v126
  v_cvt_pk_bf16_f32 v191, v128, v130
  ds_write_b128 v5, v[188:191] offset:64
  v_cvt_pk_bf16_f32 v192, -v117, -v119
  v_cvt_pk_bf16_f32 v193, -v121, -v123
  v_cvt_pk_bf16_f32 v194, -v125, -v127
  v_cvt_pk_bf16_f32 v195, -v129, -v131
  ds_write_b128 v5, v[192:195] offset:160
  v_cvt_pk_bf16_f32 v196, v132, v134
  ds_write_b32 v8, v196 offset:80
  v_cvt_pk_bf16_f32 v200, -v133, -v135
  ds_write_b32 v8, v200 offset:176
  s_waitcnt lgkmcnt(0)
  ds_read_b64_tr_b16 v[64:65], v7 offset:0
  ds_read_b64_tr_b16 v[66:67], v7 offset:2304
  ds_read_b64_tr_b16 v[52:53], v6 offset:0
  ds_read_b64_tr_b16 v[54:55], v6 offset:2304
  ds_read_b64_tr_b16 v[56:57], v6 offset:32
  ds_read_b64_tr_b16 v[58:59], v6 offset:2336
  ds_read_b64_tr_b16 v[60:61], v6 offset:64
  ds_read_b64_tr_b16 v[62:63], v6 offset:2368
  ds_read_b64_tr_b16 v[80:81], v7 offset:4608
  ds_read_b64_tr_b16 v[82:83], v7 offset:6912
  ds_read_b64_tr_b16 v[68:69], v6 offset:4608
  ds_read_b64_tr_b16 v[70:71], v6 offset:6912
  ds_read_b64_tr_b16 v[72:73], v6 offset:4640
  ds_read_b64_tr_b16 v[74:75], v6 offset:6944
  ds_read_b64_tr_b16 v[76:77], v6 offset:4672
  ds_read_b64_tr_b16 v[78:79], v6 offset:6976
  ds_read_b64_tr_b16 v[96:97], v7 offset:9216
  ds_read_b64_tr_b16 v[98:99], v7 offset:11520
  ds_read_b64_tr_b16 v[84:85], v6 offset:9216
  ds_read_b64_tr_b16 v[86:87], v6 offset:11520
  ds_read_b64_tr_b16 v[88:89], v6 offset:9248
  ds_read_b64_tr_b16 v[90:91], v6 offset:11552
  ds_read_b64_tr_b16 v[92:93], v6 offset:9280
  ds_read_b64_tr_b16 v[94:95], v6 offset:11584
  ds_read_b64_tr_b16 v[112:113], v7 offset:13824
  ds_read_b64_tr_b16 v[114:115], v7 offset:16128
  ds_read_b64_tr_b16 v[100:101], v6 offset:13824
  ds_read_b64_tr_b16 v[102:103], v6 offset:16128
  ds_read_b64_tr_b16 v[104:105], v6 offset:13856
  ds_read_b64_tr_b16 v[106:107], v6 offset:16160
  ds_read_b64_tr_b16 v[108:109], v6 offset:13888
  ds_read_b64_tr_b16 v[110:111], v6 offset:16192
  s_waitcnt lgkmcnt(15)
  v_mfma_f32_16x16x32_bf16 v[24:27], v[52:55], v[64:67], v[24:27]
  v_mfma_f32_16x16x32_bf16 v[28:31], v[56:59], v[64:67], v[28:31]
  v_mfma_f32_16x16x32_bf16 v[32:35], v[60:63], v[64:67], v[32:35]
  s_waitcnt lgkmcnt(15)
  v_mfma_f32_16x16x32_bf16 v[24:27], v[68:71], v[80:83], v[24:27]
  v_mfma_f32_16x16x32_bf16 v[28:31], v[72:75], v[80:83], v[28:31]
  v_mfma_f32_16x16x32_bf16 v[32:35], v[76:79], v[80:83], v[32:35]
  s_waitcnt lgkmcnt(8)
  v_mfma_f32_16x16x32_bf16 v[24:27], v[84:87], v[96:99], v[24:27]
  v_mfma_f32_16x16x32_bf16 v[28:31], v[88:91], v[96:99], v[28:31]
  v_mfma_f32_16x16x32_bf16 v[32:35], v[92:95], v[96:99], v[32:35]
  s_waitcnt lgkmcnt(0)
  v_mfma_f32_16x16x32_bf16 v[24:27], v[100:103], v[112:115], v[24:27]
  v_mfma_f32_16x16x32_bf16 v[28:31], v[104:107], v[112:115], v[28:31]
  v_mfma_f32_16x16x32_bf16 v[32:35], v[108:111], v[112:115], v[32:35]
  s_sub_u32 s71, s71, 1
  s_cmp_lg_u32 s71, 0
  s_nop 4
  s_cbranch_scc1 Lkg_62
  s_mov_b32 s73, 0
  s_mov_b32 s74, 22848
  s_cmp_eq_u32 s64, 1
  s_cselect_b32 s73, 32448, s73
  s_cselect_b32 s74, 41280, s74
  s_cmp_eq_u32 s64, 2
  s_cselect_b32 s73, 36864, s73
  s_cselect_b32 s74, 49728, s74
  s_cmp_eq_u32 s64, 3
  s_cselect_b32 s73, 69312, s73
  s_cselect_b32 s74, 58176, s74
  v_and_b32 v36, 15, v1
  v_lshrrev_b32 v37, 4, v1
  v_lshlrev_b32 v38, 2, v1
  v_add_u32 v38, s73, v38
  v_mov_b32 v40, 0
  s_mov_b64 s[76:77], 0xfff
  s_mov_b64 exec, s[76:77]
  ds_write_b32 v38, v40
  s_mov_b64 exec, -1
  v_lshlrev_b32 v38, 4, v36
  v_add_u32 v38, s73, v38
  v_add_u32 v38, 48, v38
  v_lshlrev_b32 v39, 10, v37
  v_add_u32 v39, v38, v39
  v_add_u32 v39, 2048, v39
  v_and_b32 v2, 1, v36
  v_lshlrev_b32 v2, 3, v2
  v_sub_u32 v3, v39, v2
  v_cvt_pk_bf16_f32 v40, v32, v32
  v_mov_b32 v41, v40
  v_cvt_pk_bf16_f32 v42, v33, v33
  v_mov_b32 v43, v42
  v_cvt_pk_bf16_f32 v44, v34, v34
  v_mov_b32 v45, v44
  v_cvt_pk_bf16_f32 v46, v35, v35
  v_mov_b32 v47, v46
  v_subrev_u32 v39, 8, v39
  s_mov_b32 exec_lo, -1
  s_mov_b32 exec_hi, 1
  ds_write_b64 v39, v[40:41] offset:0
  ds_write_b64 v39, v[40:41] offset:8
  s_mov_b32 exec_lo, -1
  s_mov_b32 exec_hi, 0
  ds_write_b64 v39, v[42:43] offset:256
  ds_write_b64 v39, v[42:43] offset:264
  s_mov_b32 exec_lo, -1
  s_mov_b32 exec_hi, 0
  ds_write_b64 v39, v[44:45] offset:512
  ds_write_b64 v39, v[44:45] offset:520
  s_mov_b32 exec_lo, -1
  s_mov_b32 exec_hi, 0
  ds_write_b64 v39, v[46:47] offset:768
  ds_write_b64 v39, v[46:47] offset:776
  s_mov_b32 exec_lo, -1
  s_mov_b32 exec_hi, 1
  ds_write_b16 v3, v40 offset:8
  s_mov_b32 exec_lo, -1
  s_mov_b32 exec_hi, 0
  ds_write_b16 v3, v42 offset:264
  s_mov_b32 exec_lo, -1
  s_mov_b32 exec_hi, 0
  ds_write_b16 v3, v44 offset:520
  s_mov_b32 exec_lo, -1
  s_mov_b32 exec_hi, 0
  ds_write_b16 v3, v46 offset:776
  s_mov_b64 exec, -1
  v_subrev_u32 v2, 2, v37
  v_lshlrev_b32 v2, 9, v2
  v_add_u32 v39, v38, v2
  v_add_u32 v39, 1020, v39
  s_mov_b32 exec_lo, 0
  s_mov_b32 exec_hi, -1
  v_cvt_pk_bf16_f32 v40, v28, v28
  v_cvt_pk_bf16_f32 v41, v28, v29
  v_cvt_pk_bf16_f32 v42, v29, v29
  ds_write_b32 v39, v40 offset:0
  ds_write_b64 v39, v[40:41] offset:4
  ds_write_b32 v39, v42 offset:12
  s_nop 1
  v_cvt_pk_bf16_f32 v40, v30, v30
  v_cvt_pk_bf16_f32 v41, v30, v31
  v_cvt_pk_bf16_f32 v42, v31, v31
  ds_write_b32 v39, v40 offset:256
  ds_write_b64 v39, v[40:41] offset:260
  ds_write_b32 v39, v42 offset:268
  s_nop 1
  s_mov_b32 exec_lo, -1
  s_mov_b32 exec_hi, 0
  v_lshlrev_b32 v2, 8, v37
  v_add_u32 v39, v38, v2
  v_add_u32 v39, 510, v39
  v_cvt_pk_bf16_f32 v40, v28, v28
  v_cvt_pk_bf16_f32 v41, v29, v30
  v_cvt_pk_bf16_f32 v42, v30, v30
  v_cvt_pk_bf16_f32 v43, v31, v31
  ds_write_b16 v39, v40
  v_add_u32 v39, 2, v39
  ds_write_b64 v39, v[40:41]
  ds_write_b32 v39, v42 offset:8
  ds_write_b16 v39, v43 offset:12
  s_mov_b64 exec, -1
  v_lshrrev_b32 v2, 1, v37
  v_lshlrev_b32 v2, 8, v2
  v_add_u32 v39, v38, v2
  v_and_b32 v2, 1, v37
  v_lshl_add_u32 v39, v2, 3, v39
  v_cvt_pk_bf16_f32 v44, v24, v25
  v_cvt_pk_bf16_f32 v45, v26, v27
  ds_write_b64 v39, v[44:45]
  s_waitcnt lgkmcnt(0)
  s_barrier
  v_lshlrev_b32 v2, 3, v0
  v_mov_b32 v40, 0
  v_mov_b32 v41, 0
  ds_write_b64 v2, v[40:41] offset:4416
  v_and_b32 v184, 15, v1
  v_lshrrev_b32 v185, 4, v1
  v_and_b32 v2, 3, v184
  v_mul_u32_u24 v56, 2112, v2
  v_lshrrev_b32 v2, 2, v184
  v_lshlrev_b32 v2, 3, v2
  v_sub_u32 v56, v56, v2
  v_lshrrev_b32 v2, 1, v185
  v_lshlrev_b32 v2, 5, v2
  v_sub_u32 v56, v56, v2
  v_and_b32 v2, 1, v185
  v_lshl_add_u32 v56, v2, 4, v56
  v_add_u32 v56, s74, v56
  v_lshlrev_b32 v2, 1, v184
  v_add_u32 v2, 32, v2
  v_and_b32 v3, 1, v185
  v_add_u32 v2, v2, v3
  v_and_b32 v3, 2, v185
  v_sub_u32 v2, v2, v3
  v_lshrrev_b32 v3, 2, v2
  v_subrev_u32 v3, 0, v3
  v_and_b32 v3, 3, v3
  v_xor_b32 v3, s64, v3
  v_lshlrev_b32 v3, 4, v3
  v_lshl_add_u32 v57, v2, 6, v3
  v_add_u32 v57, 2624, v57
  v_lshrrev_b32 v3, 2, v2
  v_subrev_u32 v3, 1, v3
  v_and_b32 v3, 3, v3
  v_xor_b32 v3, s64, v3
  v_lshlrev_b32 v3, 4, v3
  v_lshl_add_u32 v58, v2, 6, v3
  v_add_u32 v58, 2624, v58
  v_lshrrev_b32 v3, 2, v2
  v_subrev_u32 v3, 2, v3
  v_and_b32 v3, 3, v3
  v_xor_b32 v3, s64, v3
  v_lshlrev_b32 v3, 4, v3
  v_lshl_add_u32 v59, v2, 6, v3
  v_add_u32 v59, 2624, v59
  v_lshrrev_b32 v3, 2, v2
  v_subrev_u32 v3, 3, v3
  v_and_b32 v3, 3, v3
  v_xor_b32 v3, s64, v3
  v_lshlrev_b32 v3, 4, v3
  v_lshl_add_u32 v60, v2, 6, v3
  v_add_u32 v60, 2624, v60
  v_lshlrev_b32 v61, 4, v1
  v_add_u32 v61, s74, v61
  v_lshlrev_b32 v63, 4, v1
  s_mov_b32 s78, 0xffff
  s_add_u32 s66, s73, 2072
  v_sub_u32 v62, s66, v63
  ds_read_b64 v[160:161], v62
  ds_read_b128 v[162:165], v62 offset:8
  s_waitcnt lgkmcnt(0)
  v_bfi_b32 v168, s78, v164, v163
  v_alignbit_b32 v172, v164, v164, 16
  v_bfi_b32 v176, s78, v165, v164
  v_alignbit_b32 v180, v165, v165, 16
  v_bfi_b32 v169, s78, v163, v162
  v_alignbit_b32 v173, v163, v163, 16
  v_bfi_b32 v177, s78, v164, v163
  v_alignbit_b32 v181, v164, v164, 16
  v_bfi_b32 v170, s78, v162, v161
  v_alignbit_b32 v174, v162, v162, 16
  v_bfi_b32 v178, s78, v163, v162
  v_alignbit_b32 v182, v163, v163, 16
  v_bfi_b32 v171, s78, v161, v160
  v_alignbit_b32 v175, v161, v161, 16
  v_bfi_b32 v179, s78, v162, v161
  v_alignbit_b32 v183, v162, v162, 16
  ds_write_b128 v61, v[168:171] offset:0
  ds_write_b128 v61, v[172:175] offset:2112
  ds_write_b128 v61, v[176:179] offset:4224
  ds_write_b128 v61, v[180:183] offset:6336
  s_add_u32 s66, s73, 1048
  v_sub_u32 v62, s66, v63
  ds_read_b64 v[160:161], v62
  ds_read_b128 v[162:165], v62 offset:8
  s_waitcnt lgkmcnt(0)
  v_bfi_b32 v168, s78, v164, v163
  v_alignbit_b32 v172, v164, v164, 16
  v_bfi_b32 v176, s78, v165, v164
  v_alignbit_b32 v180, v165, v165, 16
  v_bfi_b32 v169, s78, v163, v162
  v_alignbit_b32 v173, v163, v163, 16
  v_bfi_b32 v177, s78, v164, v163
  v_alignbit_b32 v181, v164, v164, 16
  v_bfi_b32 v170, s78, v162, v161
  v_alignbit_b32 v174, v162, v162, 16
  v_bfi_b32 v178, s78, v163, v162
  v_alignbit_b32 v182, v163, v163, 16
  v_bfi_b32 v171, s78, v161, v160
  v_alignbit_b32 v175, v161, v161, 16
  v_bfi_b32 v179, s78, v162, v161
  v_alignbit_b32 v183, v162, v162, 16
  ds_write_b128 v61, v[168:171] offset:1024
  ds_write_b128 v61, v[172:175] offset:3136
  ds_write_b128 v61, v[176:179] offset:5248
  ds_write_b128 v61, v[180:183] offset:7360
  s_mov_b32 exec_lo, 3
  s_mov_b32 exec_hi, 0
  s_add_u32 s66, s73, 24
  v_sub_u32 v62, s66, v63
  ds_read_b64 v[160:161], v62
  ds_read_b128 v[162:165], v62 offset:8
  s_waitcnt lgkmcnt(0)
  v_bfi_b32 v168, s78, v164, v163
  v_alignbit_b32 v172, v164, v164, 16
  v_bfi_b32 v176, s78, v165, v164
  v_alignbit_b32 v180, v165, v165, 16
  v_bfi_b32 v169, s78, v163, v162
  v_alignbit_b32 v173, v163, v163, 16
  v_bfi_b32 v177, s78, v164, v163
  v_alignbit_b32 v181, v164, v164, 16
  v_bfi_b32 v170, s78, v162, v161
  v_alignbit_b32 v174, v162, v162, 16
  v_bfi_b32 v178, s78, v163, v162
  v_alignbit_b32 v182, v163, v163, 16
  v_bfi_b32 v171, s78, v161, v160
  v_alignbit_b32 v175, v161, v161, 16
  v_bfi_b32 v179, s78, v162, v161
  v_alignbit_b32 v183, v162, v162, 16
  ds_write_b128 v61, v[168:171] offset:2048
  ds_write_b128 v61, v[172:175] offset:4160
  ds_write_b128 v61, v[176:179] offset:6272
  ds_write_b128 v61, v[180:183] offset:8384
  s_mov_b64 exec, -1
  s_waitcnt lgkmcnt(0)
  s_waitcnt vmcnt(0)
  v_readfirstlane_b32 s40, v254
  s_nop 3
  s_add_u32 s40, s40, 0x9e3779b1
  s_setprio 0
  v_and_b32 v44, 31, v0
  s_lshl_b32 s66, s64, 5
  v_add_u32 v44, s66, v44
  v_lshlrev_b32 v44, 6, v44
  v_add_u32 v44, 14761984, v44
  s_mov_b32 exec_lo, 0xffffffff
  s_mov_b32 exec_hi, 0x0
  s_mov_b32 s41, 0x40000
  s_branch Lpf_65
Lpoll_63:
  s_sleep 32
Lpf_65:
  buffer_load_dword v46, v44, s[32:35], 0 offen sc1
  s_sub_u32 s41, s41, 1
  s_cbranch_scc1 Lpout_64
  s_waitcnt vmcnt(0)
  v_cmp_ne_u32 vcc, s40, v46
  s_nop 3
  s_mov_b64 s[44:45], vcc
  s_cmp_lg_u64 s[44:45], 0
  s_cbranch_scc1 Lpoll_63
Lpout_64:
  s_waitcnt vmcnt(0)
  s_mov_b64 exec, -1
  s_barrier
  v_lshrrev_b32 v2, 2, v1
  v_lshlrev_b32 v36, 7, v2
  v_bfe_u32 v2, v1, 4, 2
  v_and_b32 v3, 3, v1
  v_xor_b32 v2, v2, v3
  v_lshl_add_u32 v36, v2, 4, v36
  s_lshr_b32 s66, s46, 1
  s_lshl_b32 s66, s66, 15
  s_and_b32 s67, s46, 1
  s_lshl_b32 s67, s67, 6
  s_add_u32 s66, s66, s67
  s_lshl_b32 s67, s64, 13
  s_add_u32 s66, s66, s67
  s_lshl_b32 s67, s64, 12
  s_add_u32 s67, s67, 6464
  s_add_u32 m0, s67, 0
  s_nop 0
  buffer_load_dwordx4 v36, s[32:35], s66 offen sc1 lds
  s_add_u32 s66, s66, 2048
  s_add_u32 m0, s67, 1024
  s_nop 0
  buffer_load_dwordx4 v36, s[32:35], s66 offen sc1 lds
  s_add_u32 s66, s66, 2048
  s_add_u32 m0, s67, 2048
  s_nop 0
  buffer_load_dwordx4 v36, s[32:35], s66 offen sc1 lds
  s_add_u32 s66, s66, 2048
  s_add_u32 m0, s67, 3072
  s_nop 0
  buffer_load_dwordx4 v36, s[32:35], s66 offen sc1 lds
  s_waitcnt vmcnt(0) lgkmcnt(0)
  s_barrier
  ds_read_b64 v[64:65], v56 offset:2040
  ds_read_b64 v[66:67], v56 offset:2048
  ds_read_b64 v[68:69], v56 offset:1528
  ds_read_b64 v[70:71], v56 offset:1536
  ds_read_b64 v[72:73], v56 offset:1016
  ds_read_b64 v[74:75], v56 offset:1024
  ds_read_b64 v[76:77], v56 offset:504
  ds_read_b64 v[78:79], v56 offset:512
  ds_read_b128 v[96:99], v57 offset:1792
  ds_read_b128 v[100:103], v57 offset:3840
  ds_read_b128 v[104:107], v57 offset:5888
  ds_read_b128 v[108:111], v57 offset:7936
  ds_read_b128 v[112:115], v57 offset:9984
  ds_read_b128 v[116:119], v57 offset:12032
  ds_read_b128 v[120:123], v57 offset:14080
  ds_read_b128 v[124:127], v57 offset:16128
  s_waitcnt lgkmcnt(0)
  v_mfma_f32_16x16x32_bf16 v[24:27], v[64:67], v[96:99], 0
  ds_read_b64 v[80:81], v56 offset:1976
  v_mfma_f32_16x16x32_bf16 v[28:31], v[64:67], v[100:103], 0
  ds_read_b64 v[82:83], v56 offset:1984
  v_mfma_f32_16x16x32_bf16 v[32:35], v[64:67], v[104:107], 0
  ds_read_b64 v[84:85], v56 offset:1464
  v_mfma_f32_16x16x32_bf16 v[36:39], v[64:67], v[108:111], 0
  ds_read_b64 v[86:87], v56 offset:1472
  v_mfma_f32_16x16x32_bf16 v[40:43], v[64:67], v[112:115], 0
  ds_read_b64 v[88:89], v56 offset:952
  v_mfma_f32_16x16x32_bf16 v[44:47], v[64:67], v[116:119], 0
  ds_read_b64 v[90:91], v56 offset:960
  v_mfma_f32_16x16x32_bf16 v[48:51], v[64:67], v[120:123], 0
  ds_read_b64 v[92:93], v56 offset:440
  v_mfma_f32_16x16x32_bf16 v[52:55], v[64:67], v[124:127], 0
  ds_read_b64 v[94:95], v56 offset:448
  v_mfma_f32_16x16x32_bf16 v[28:31], v[68:71], v[96:99], v[28:31]
  ds_read_b128 v[128:131], v58 offset:1536
  v_mfma_f32_16x16x32_bf16 v[32:35], v[68:71], v[100:103], v[32:35]
  ds_read_b128 v[132:135], v58 offset:3584
  v_mfma_f32_16x16x32_bf16 v[36:39], v[68:71], v[104:107], v[36:39]
  ds_read_b128 v[136:139], v58 offset:5632
  v_mfma_f32_16x16x32_bf16 v[40:43], v[68:71], v[108:111], v[40:43]
  ds_read_b128 v[140:143], v58 offset:7680
  v_mfma_f32_16x16x32_bf16 v[44:47], v[68:71], v[112:115], v[44:47]
  ds_read_b128 v[144:147], v58 offset:9728
  v_mfma_f32_16x16x32_bf16 v[48:51], v[68:71], v[116:119], v[48:51]
  ds_read_b128 v[148:151], v58 offset:11776
  v_mfma_f32_16x16x32_bf16 v[52:55], v[68:71], v[120:123], v[52:55]
  ds_read_b128 v[152:155], v58 offset:13824
  v_mfma_f32_16x16x32_bf16 v[32:35], v[72:75], v[96:99], v[32:35]
  ds_read_b128 v[156:159], v58 offset:15872
  v_mfma_f32_16x16x32_bf16 v[36:39], v[72:75], v[100:103], v[36:39]
  v_mfma_f32_16x16x32_bf16 v[40:43], v[72:75], v[104:107], v[40:43]
  v_mfma_f32_16x16x32_bf16 v[44:47], v[72:75], v[108:111], v[44:47]
  v_mfma_f32_16x16x32_bf16 v[48:51], v[72:75], v[112:115], v[48:51]
  v_mfma_f32_16x16x32_bf16 v[52:55], v[72:75], v[116:119], v[52:55]
  v_mfma_f32_16x16x32_bf16 v[36:39], v[76:79], v[96:99], v[36:39]
  v_mfma_f32_16x16x32_bf16 v[40:43], v[76:79], v[100:103], v[40:43]
  v_mfma_f32_16x16x32_bf16 v[44:47], v[76:79], v[104:107], v[44:47]
  v_mfma_f32_16x16x32_bf16 v[48:51], v[76:79], v[108:111], v[48:51]
  v_mfma_f32_16x16x32_bf16 v[52:55], v[76:79], v[112:115], v[52:55]
  s_waitcnt lgkmcnt(0)
  v_mfma_f32_16x16x32_bf16 v[24:27], v[80:83], v[128:131], v[24:27]
  ds_read_b64 v[64:65], v56 offset:1912
  v_mfma_f32_16x16x32_bf16 v[28:31], v[80:83], v[132:135], v[28:31]
  ds_read_b64 v[66:67], v56 offset:1920
  v_mfma_f32_16x16x32_bf16 v[32:35], v[80:83], v[136:139], v[32:35]
  ds_read_b64 v[68:69], v56 offset:1400
  v_mfma_f32_16x16x32_bf16 v[36:39], v[80:83], v[140:143], v[36:39]
  ds_read_b64 v[70:71], v56 offset:1408
  v_mfma_f32_16x16x32_bf16 v[40:43], v[80:83], v[144:147], v[40:43]
  ds_read_b64 v[72:73], v56 offset:888
  v_mfma_f32_16x16x32_bf16 v[44:47], v[80:83], v[148:151], v[44:47]
  ds_read_b64 v[74:75], v56 offset:896
  v_mfma_f32_16x16x32_bf16 v[48:51], v[80:83], v[152:155], v[48:51]
  ds_read_b64 v[76:77], v56 offset:376
  v_mfma_f32_16x16x32_bf16 v[52:55], v[80:83], v[156:159], v[52:55]
  ds_read_b64 v[78:79], v56 offset:384
  v_mfma_f32_16x16x32_bf16 v[28:31], v[84:87], v[128:131], v[28:31]
  ds_read_b128 v[96:99], v59 offset:1280
  v_mfma_f32_16x16x32_bf16 v[32:35], v[84:87], v[132:135], v[32:35]
  ds_read_b128 v[100:103], v59 offset:3328
  v_mfma_f32_16x16x32_bf16 v[36:39], v[84:87], v[136:139], v[36:39]
  ds_read_b128 v[104:107], v59 offset:5376
  v_mfma_f32_16x16x32_bf16 v[40:43], v[84:87], v[140:143], v[40:43]
  ds_read_b128 v[108:111], v59 offset:7424
  v_mfma_f32_16x16x32_bf16 v[44:47], v[84:87], v[144:147], v[44:47]
  ds_read_b128 v[112:115], v59 offset:9472
  v_mfma_f32_16x16x32_bf16 v[48:51], v[84:87], v[148:151], v[48:51]
  ds_read_b128 v[116:119], v59 offset:11520
  v_mfma_f32_16x16x32_bf16 v[52:55], v[84:87], v[152:155], v[52:55]
  ds_read_b128 v[120:123], v59 offset:13568
  v_mfma_f32_16x16x32_bf16 v[32:35], v[88:91], v[128:131], v[32:35]
  ds_read_b128 v[124:127], v59 offset:15616
  v_mfma_f32_16x16x32_bf16 v[36:39], v[88:91], v[132:135], v[36:39]
  v_mfma_f32_16x16x32_bf16 v[40:43], v[88:91], v[136:139], v[40:43]
  v_mfma_f32_16x16x32_bf16 v[44:47], v[88:91], v[140:143], v[44:47]
  v_mfma_f32_16x16x32_bf16 v[48:51], v[88:91], v[144:147], v[48:51]
  v_mfma_f32_16x16x32_bf16 v[52:55], v[88:91], v[148:151], v[52:55]
  v_mfma_f32_16x16x32_bf16 v[36:39], v[92:95], v[128:131], v[36:39]
  v_mfma_f32_16x16x32_bf16 v[40:43], v[92:95], v[132:135], v[40:43]
  v_mfma_f32_16x16x32_bf16 v[44:47], v[92:95], v[136:139], v[44:47]
  v_mfma_f32_16x16x32_bf16 v[48:51], v[92:95], v[140:143], v[48:51]
  v_mfma_f32_16x16x32_bf16 v[52:55], v[92:95], v[144:147], v[52:55]
  s_waitcnt lgkmcnt(0)
  v_mfma_f32_16x16x32_bf16 v[24:27], v[64:67], v[96:99], v[24:27]
  ds_read_b64 v[80:81], v56 offset:1848
  v_mfma_f32_16x16x32_bf16 v[28:31], v[64:67], v[100:103], v[28:31]
  ds_read_b64 v[82:83], v56 offset:1856
  v_mfma_f32_16x16x32_bf16 v[32:35], v[64:67], v[104:107], v[32:35]
  ds_read_b64 v[84:85], v56 offset:1336
  v_mfma_f32_16x16x32_bf16 v[36:39], v[64:67], v[108:111], v[36:39]
  ds_read_b64 v[86:87], v56 offset:1344
  v_mfma_f32_16x16x32_bf16 v[40:43], v[64:67], v[112:115], v[40:43]
  ds_read_b64 v[88:89], v56 offset:824
  v_mfma_f32_16x16x32_bf16 v[44:47], v[64:67], v[116:119], v[44:47]
  ds_read_b64 v[90:91], v56 offset:832
  v_mfma_f32_16x16x32_bf16 v[48:51], v[64:67], v[120:123], v[48:51]
  ds_read_b64 v[92:93], v56 offset:312
  v_mfma_f32_16x16x32_bf16 v[52:55], v[64:67], v[124:127], v[52:55]
  ds_read_b64 v[94:95], v56 offset:320
  v_mfma_f32_16x16x32_bf16 v[28:31], v[68:71], v[96:99], v[28:31]
  ds_read_b128 v[128:131], v60 offset:1024
  v_mfma_f32_16x16x32_bf16 v[32:35], v[68:71], v[100:103], v[32:35]
  ds_read_b128 v[132:135], v60 offset:3072
  v_mfma_f32_16x16x32_bf16 v[36:39], v[68:71], v[104:107], v[36:39]
  ds_read_b128 v[136:139], v60 offset:5120
  v_mfma_f32_16x16x32_bf16 v[40:43], v[68:71], v[108:111], v[40:43]
  ds_read_b128 v[140:143], v60 offset:7168
  v_mfma_f32_16x16x32_bf16 v[44:47], v[68:71], v[112:115], v[44:47]
  ds_read_b128 v[144:147], v60 offset:9216
  v_mfma_f32_16x16x32_bf16 v[48:51], v[68:71], v[116:119], v[48:51]
  ds_read_b128 v[148:151], v60 offset:11264
  v_mfma_f32_16x16x32_bf16 v[52:55], v[68:71], v[120:123], v[52:55]
  ds_read_b128 v[152:155], v60 offset:13312
  v_mfma_f32_16x16x32_bf16 v[32:35], v[72:75], v[96:99], v[32:35]
  ds_read_b128 v[156:159], v60 offset:15360
  v_mfma_f32_16x16x32_bf16 v[36:39], v[72:75], v[100:103], v[36:39]
  v_mfma_f32_16x16x32_bf16 v[40:43], v[72:75], v[104:107], v[40:43]
  v_mfma_f32_16x16x32_bf16 v[44:47], v[72:75], v[108:111], v[44:47]
  v_mfma_f32_16x16x32_bf16 v[48:51], v[72:75], v[112:115], v[48:51]
  v_mfma_f32_16x16x32_bf16 v[52:55], v[72:75], v[116:119], v[52:55]
  v_mfma_f32_16x16x32_bf16 v[36:39], v[76:79], v[96:99], v[36:39]
  v_mfma_f32_16x16x32_bf16 v[40:43], v[76:79], v[100:103], v[40:43]
  v_mfma_f32_16x16x32_bf16 v[44:47], v[76:79], v[104:107], v[44:47]
  v_mfma_f32_16x16x32_bf16 v[48:51], v[76:79], v[108:111], v[48:51]
  v_mfma_f32_16x16x32_bf16 v[52:55], v[76:79], v[112:115], v[52:55]
  s_waitcnt lgkmcnt(0)
  v_mfma_f32_16x16x32_bf16 v[24:27], v[80:83], v[128:131], v[24:27]
  ds_read_b64 v[64:65], v56 offset:1784
  v_mfma_f32_16x16x32_bf16 v[28:31], v[80:83], v[132:135], v[28:31]
  ds_read_b64 v[66:67], v56 offset:1792
  v_mfma_f32_16x16x32_bf16 v[32:35], v[80:83], v[136:139], v[32:35]
  ds_read_b64 v[68:69], v56 offset:1272
  v_mfma_f32_16x16x32_bf16 v[36:39], v[80:83], v[140:143], v[36:39]
  ds_read_b64 v[70:71], v56 offset:1280
  v_mfma_f32_16x16x32_bf16 v[40:43], v[80:83], v[144:147], v[40:43]
  ds_read_b64 v[72:73], v56 offset:760
  v_mfma_f32_16x16x32_bf16 v[44:47], v[80:83], v[148:151], v[44:47]
  ds_read_b64 v[74:75], v56 offset:768
  v_mfma_f32_16x16x32_bf16 v[48:51], v[80:83], v[152:155], v[48:51]
  ds_read_b64 v[76:77], v56 offset:248
  v_mfma_f32_16x16x32_bf16 v[52:55], v[80:83], v[156:159], v[52:55]
  ds_read_b64 v[78:79], v56 offset:256
  v_mfma_f32_16x16x32_bf16 v[28:31], v[84:87], v[128:131], v[28:31]
  ds_read_b128 v[96:99], v57 offset:768
  v_mfma_f32_16x16x32_bf16 v[32:35], v[84:87], v[132:135], v[32:35]
  ds_read_b128 v[100:103], v57 offset:2816
  v_mfma_f32_16x16x32_bf16 v[36:39], v[84:87], v[136:139], v[36:39]
  ds_read_b128 v[104:107], v57 offset:4864
  v_mfma_f32_16x16x32_bf16 v[40:43], v[84:87], v[140:143], v[40:43]
  ds_read_b128 v[108:111], v57 offset:6912
  v_mfma_f32_16x16x32_bf16 v[44:47], v[84:87], v[144:147], v[44:47]
  ds_read_b128 v[112:115], v57 offset:8960
  v_mfma_f32_16x16x32_bf16 v[48:51], v[84:87], v[148:151], v[48:51]
  ds_read_b128 v[116:119], v57 offset:11008
  v_mfma_f32_16x16x32_bf16 v[52:55], v[84:87], v[152:155], v[52:55]
  ds_read_b128 v[120:123], v57 offset:13056
  v_mfma_f32_16x16x32_bf16 v[32:35], v[88:91], v[128:131], v[32:35]
  ds_read_b128 v[124:127], v57 offset:15104
  v_mfma_f32_16x16x32_bf16 v[36:39], v[88:91], v[132:135], v[36:39]
  v_mfma_f32_16x16x32_bf16 v[40:43], v[88:91], v[136:139], v[40:43]
  v_mfma_f32_16x16x32_bf16 v[44:47], v[88:91], v[140:143], v[44:47]
  v_mfma_f32_16x16x32_bf16 v[48:51], v[88:91], v[144:147], v[48:51]
  v_mfma_f32_16x16x32_bf16 v[52:55], v[88:91], v[148:151], v[52:55]
  v_mfma_f32_16x16x32_bf16 v[36:39], v[92:95], v[128:131], v[36:39]
  v_mfma_f32_16x16x32_bf16 v[40:43], v[92:95], v[132:135], v[40:43]
  v_mfma_f32_16x16x32_bf16 v[44:47], v[92:95], v[136:139], v[44:47]
  v_mfma_f32_16x16x32_bf16 v[48:51], v[92:95], v[140:143], v[48:51]
  v_mfma_f32_16x16x32_bf16 v[52:55], v[92:95], v[144:147], v[52:55]
  s_waitcnt lgkmcnt(0)
  v_mfma_f32_16x16x32_bf16 v[24:27], v[64:67], v[96:99], v[24:27]
  ds_read_b64 v[80:81], v56 offset:1720
  v_mfma_f32_16x16x32_bf16 v[28:31], v[64:67], v[100:103], v[28:31]
  ds_read_b64 v[82:83], v56 offset:1728
  v_mfma_f32_16x16x32_bf16 v[32:35], v[64:67], v[104:107], v[32:35]
  ds_read_b64 v[84:85], v56 offset:1208
  v_mfma_f32_16x16x32_bf16 v[36:39], v[64:67], v[108:111], v[36:39]
  ds_read_b64 v[86:87], v56 offset:1216
  v_mfma_f32_16x16x32_bf16 v[40:43], v[64:67], v[112:115], v[40:43]
  ds_read_b64 v[88:89], v56 offset:696
  v_mfma_f32_16x16x32_bf16 v[44:47], v[64:67], v[116:119], v[44:47]
  ds_read_b64 v[90:91], v56 offset:704
  v_mfma_f32_16x16x32_bf16 v[48:51], v[64:67], v[120:123], v[48:51]
  ds_read_b64 v[92:93], v56 offset:184
  v_mfma_f32_16x16x32_bf16 v[52:55], v[64:67], v[124:127], v[52:55]
  ds_read_b64 v[94:95], v56 offset:192
  v_mfma_f32_16x16x32_bf16 v[28:31], v[68:71], v[96:99], v[28:31]
  ds_read_b128 v[128:131], v58 offset:512
  v_mfma_f32_16x16x32_bf16 v[32:35], v[68:71], v[100:103], v[32:35]
  ds_read_b128 v[132:135], v58 offset:2560
  v_mfma_f32_16x16x32_bf16 v[36:39], v[68:71], v[104:107], v[36:39]
  ds_read_b128 v[136:139], v58 offset:4608
  v_mfma_f32_16x16x32_bf16 v[40:43], v[68:71], v[108:111], v[40:43]
  ds_read_b128 v[140:143], v58 offset:6656
  v_mfma_f32_16x16x32_bf16 v[44:47], v[68:71], v[112:115], v[44:47]
  ds_read_b128 v[144:147], v58 offset:8704
  v_mfma_f32_16x16x32_bf16 v[48:51], v[68:71], v[116:119], v[48:51]
  ds_read_b128 v[148:151], v58 offset:10752
  v_mfma_f32_16x16x32_bf16 v[52:55], v[68:71], v[120:123], v[52:55]
  ds_read_b128 v[152:155], v58 offset:12800
  v_mfma_f32_16x16x32_bf16 v[32:35], v[72:75], v[96:99], v[32:35]
  ds_read_b128 v[156:159], v58 offset:14848
  v_mfma_f32_16x16x32_bf16 v[36:39], v[72:75], v[100:103], v[36:39]
  v_mfma_f32_16x16x32_bf16 v[40:43], v[72:75], v[104:107], v[40:43]
  v_mfma_f32_16x16x32_bf16 v[44:47], v[72:75], v[108:111], v[44:47]
  v_mfma_f32_16x16x32_bf16 v[48:51], v[72:75], v[112:115], v[48:51]
  v_mfma_f32_16x16x32_bf16 v[52:55], v[72:75], v[116:119], v[52:55]
  v_mfma_f32_16x16x32_bf16 v[36:39], v[76:79], v[96:99], v[36:39]
  v_mfma_f32_16x16x32_bf16 v[40:43], v[76:79], v[100:103], v[40:43]
  v_mfma_f32_16x16x32_bf16 v[44:47], v[76:79], v[104:107], v[44:47]
  v_mfma_f32_16x16x32_bf16 v[48:51], v[76:79], v[108:111], v[48:51]
  v_mfma_f32_16x16x32_bf16 v[52:55], v[76:79], v[112:115], v[52:55]
  s_waitcnt lgkmcnt(0)
  v_mfma_f32_16x16x32_bf16 v[24:27], v[80:83], v[128:131], v[24:27]
  ds_read_b64 v[64:65], v56 offset:1656
  v_mfma_f32_16x16x32_bf16 v[28:31], v[80:83], v[132:135], v[28:31]
  ds_read_b64 v[66:67], v56 offset:1664
  v_mfma_f32_16x16x32_bf16 v[32:35], v[80:83], v[136:139], v[32:35]
  ds_read_b64 v[68:69], v56 offset:1144
  v_mfma_f32_16x16x32_bf16 v[36:39], v[80:83], v[140:143], v[36:39]
  ds_read_b64 v[70:71], v56 offset:1152
  v_mfma_f32_16x16x32_bf16 v[40:43], v[80:83], v[144:147], v[40:43]
  ds_read_b64 v[72:73], v56 offset:632
  v_mfma_f32_16x16x32_bf16 v[44:47], v[80:83], v[148:151], v[44:47]
  ds_read_b64 v[74:75], v56 offset:640
  v_mfma_f32_16x16x32_bf16 v[48:51], v[80:83], v[152:155], v[48:51]
  ds_read_b64 v[76:77], v56 offset:120
  v_mfma_f32_16x16x32_bf16 v[52:55], v[80:83], v[156:159], v[52:55]
  ds_read_b64 v[78:79], v56 offset:128
  v_mfma_f32_16x16x32_bf16 v[28:31], v[84:87], v[128:131], v[28:31]
  ds_read_b128 v[96:99], v59 offset:256
  v_mfma_f32_16x16x32_bf16 v[32:35], v[84:87], v[132:135], v[32:35]
  ds_read_b128 v[100:103], v59 offset:2304
  v_mfma_f32_16x16x32_bf16 v[36:39], v[84:87], v[136:139], v[36:39]
  ds_read_b128 v[104:107], v59 offset:4352
  v_mfma_f32_16x16x32_bf16 v[40:43], v[84:87], v[140:143], v[40:43]
  ds_read_b128 v[108:111], v59 offset:6400
  v_mfma_f32_16x16x32_bf16 v[44:47], v[84:87], v[144:147], v[44:47]
  ds_read_b128 v[112:115], v59 offset:8448
  v_mfma_f32_16x16x32_bf16 v[48:51], v[84:87], v[148:151], v[48:51]
  ds_read_b128 v[116:119], v59 offset:10496
  v_mfma_f32_16x16x32_bf16 v[52:55], v[84:87], v[152:155], v[52:55]
  ds_read_b128 v[120:123], v59 offset:12544
  v_mfma_f32_16x16x32_bf16 v[32:35], v[88:91], v[128:131], v[32:35]
  ds_read_b128 v[124:127], v59 offset:14592
  v_mfma_f32_16x16x32_bf16 v[36:39], v[88:91], v[132:135], v[36:39]
  v_mfma_f32_16x16x32_bf16 v[40:43], v[88:91], v[136:139], v[40:43]
  v_mfma_f32_16x16x32_bf16 v[44:47], v[88:91], v[140:143], v[44:47]
  v_mfma_f32_16x16x32_bf16 v[48:51], v[88:91], v[144:147], v[48:51]
  v_mfma_f32_16x16x32_bf16 v[52:55], v[88:91], v[148:151], v[52:55]
  v_mfma_f32_16x16x32_bf16 v[36:39], v[92:95], v[128:131], v[36:39]
  v_mfma_f32_16x16x32_bf16 v[40:43], v[92:95], v[132:135], v[40:43]
  v_mfma_f32_16x16x32_bf16 v[44:47], v[92:95], v[136:139], v[44:47]
  v_mfma_f32_16x16x32_bf16 v[48:51], v[92:95], v[140:143], v[48:51]
  v_mfma_f32_16x16x32_bf16 v[52:55], v[92:95], v[144:147], v[52:55]
  s_waitcnt lgkmcnt(0)
  v_mfma_f32_16x16x32_bf16 v[24:27], v[64:67], v[96:99], v[24:27]
  ds_read_b64 v[80:81], v56 offset:1592
  v_mfma_f32_16x16x32_bf16 v[28:31], v[64:67], v[100:103], v[28:31]
  ds_read_b64 v[82:83], v56 offset:1600
  v_mfma_f32_16x16x32_bf16 v[32:35], v[64:67], v[104:107], v[32:35]
  ds_read_b64 v[84:85], v56 offset:1080
  v_mfma_f32_16x16x32_bf16 v[36:39], v[64:67], v[108:111], v[36:39]
  ds_read_b64 v[86:87], v56 offset:1088
  v_mfma_f32_16x16x32_bf16 v[40:43], v[64:67], v[112:115], v[40:43]
  ds_read_b64 v[88:89], v56 offset:568
  v_mfma_f32_16x16x32_bf16 v[44:47], v[64:67], v[116:119], v[44:47]
  ds_read_b64 v[90:91], v56 offset:576
  v_mfma_f32_16x16x32_bf16 v[48:51], v[64:67], v[120:123], v[48:51]
  ds_read_b64 v[92:93], v56 offset:56
  v_mfma_f32_16x16x32_bf16 v[52:55], v[64:67], v[124:127], v[52:55]
  ds_read_b64 v[94:95], v56 offset:64
  v_mfma_f32_16x16x32_bf16 v[28:31], v[68:71], v[96:99], v[28:31]
  ds_read_b128 v[128:131], v60 offset:0
  v_mfma_f32_16x16x32_bf16 v[32:35], v[68:71], v[100:103], v[32:35]
  ds_read_b128 v[132:135], v60 offset:2048
  v_mfma_f32_16x16x32_bf16 v[36:39], v[68:71], v[104:107], v[36:39]
  ds_read_b128 v[136:139], v60 offset:4096
  v_mfma_f32_16x16x32_bf16 v[40:43], v[68:71], v[108:111], v[40:43]
  ds_read_b128 v[140:143], v60 offset:6144
  v_mfma_f32_16x16x32_bf16 v[44:47], v[68:71], v[112:115], v[44:47]
  ds_read_b128 v[144:147], v60 offset:8192
  v_mfma_f32_16x16x32_bf16 v[48:51], v[68:71], v[116:119], v[48:51]
  ds_read_b128 v[148:151], v60 offset:10240
  v_mfma_f32_16x16x32_bf16 v[52:55], v[68:71], v[120:123], v[52:55]
  ds_read_b128 v[152:155], v60 offset:12288
  v_mfma_f32_16x16x32_bf16 v[32:35], v[72:75], v[96:99], v[32:35]
  ds_read_b128 v[156:159], v60 offset:14336
  v_mfma_f32_16x16x32_bf16 v[36:39], v[72:75], v[100:103], v[36:39]
  v_mfma_f32_16x16x32_bf16 v[40:43], v[72:75], v[104:107], v[40:43]
  v_mfma_f32_16x16x32_bf16 v[44:47], v[72:75], v[108:111], v[44:47]
  v_mfma_f32_16x16x32_bf16 v[48:51], v[72:75], v[112:115], v[48:51]
  v_mfma_f32_16x16x32_bf16 v[52:55], v[72:75], v[116:119], v[52:55]
  v_mfma_f32_16x16x32_bf16 v[36:39], v[76:79], v[96:99], v[36:39]
  v_mfma_f32_16x16x32_bf16 v[40:43], v[76:79], v[100:103], v[40:43]
  v_mfma_f32_16x16x32_bf16 v[44:47], v[76:79], v[104:107], v[44:47]
  v_mfma_f32_16x16x32_bf16 v[48:51], v[76:79], v[108:111], v[48:51]
  v_mfma_f32_16x16x32_bf16 v[52:55], v[76:79], v[112:115], v[52:55]
  s_waitcnt lgkmcnt(0)
  v_mfma_f32_16x16x32_bf16 v[24:27], v[80:83], v[128:131], v[24:27]
  v_mfma_f32_16x16x32_bf16 v[28:31], v[80:83], v[132:135], v[28:31]
  v_mfma_f32_16x16x32_bf16 v[32:35], v[80:83], v[136:139], v[32:35]
  v_mfma_f32_16x16x32_bf16 v[36:39], v[80:83], v[140:143], v[36:39]
  v_mfma_f32_16x16x32_bf16 v[40:43], v[80:83], v[144:147], v[40:43]
  v_mfma_f32_16x16x32_bf16 v[44:47], v[80:83], v[148:151], v[44:47]
  v_mfma_f32_16x16x32_bf16 v[48:51], v[80:83], v[152:155], v[48:51]
  v_mfma_f32_16x16x32_bf16 v[52:55], v[80:83], v[156:159], v[52:55]
  v_mfma_f32_16x16x32_bf16 v[28:31], v[84:87], v[128:131], v[28:31]
  v_mfma_f32_16x16x32_bf16 v[32:35], v[84:87], v[132:135], v[32:35]
  v_mfma_f32_16x16x32_bf16 v[36:39], v[84:87], v[136:139], v[36:39]
  v_mfma_f32_16x16x32_bf16 v[40:43], v[84:87], v[140:143], v[40:43]
  v_mfma_f32_16x16x32_bf16 v[44:47], v[84:87], v[144:147], v[44:47]
  v_mfma_f32_16x16x32_bf16 v[48:51], v[84:87], v[148:151], v[48:51]
  v_mfma_f32_16x16x32_bf16 v[52:55], v[84:87], v[152:155], v[52:55]
  v_mfma_f32_16x16x32_bf16 v[32:35], v[88:91], v[128:131], v[32:35]
  v_mfma_f32_16x16x32_bf16 v[36:39], v[88:91], v[132:135], v[36:39]
  v_mfma_f32_16x16x32_bf16 v[40:43], v[88:91], v[136:139], v[40:43]
  v_mfma_f32_16x16x32_bf16 v[44:47], v[88:91], v[140:143], v[44:47]
  v_mfma_f32_16x16x32_bf16 v[48:51], v[88:91], v[144:147], v[48:51]
  v_mfma_f32_16x16x32_bf16 v[52:55], v[88:91], v[148:151], v[52:55]
  v_mfma_f32_16x16x32_bf16 v[36:39], v[92:95], v[128:131], v[36:39]
  v_mfma_f32_16x16x32_bf16 v[40:43], v[92:95], v[132:135], v[40:43]
  v_mfma_f32_16x16x32_bf16 v[44:47], v[92:95], v[136:139], v[44:47]
  v_mfma_f32_16x16x32_bf16 v[48:51], v[92:95], v[140:143], v[48:51]
  v_mfma_f32_16x16x32_bf16 v[52:55], v[92:95], v[144:147], v[52:55]
  s_add_u32 s66, s73, 4120
  v_sub_u32 v62, s66, v63
  ds_read_b64 v[160:161], v62
  ds_read_b128 v[162:165], v62 offset:8
  s_waitcnt lgkmcnt(0)
  v_bfi_b32 v168, s78, v164, v163
  v_alignbit_b32 v172, v164, v164, 16
  v_bfi_b32 v176, s78, v165, v164
  v_alignbit_b32 v180, v165, v165, 16
  v_bfi_b32 v169, s78, v163, v162
  v_alignbit_b32 v173, v163, v163, 16
  v_bfi_b32 v177, s78, v164, v163
  v_alignbit_b32 v181, v164, v164, 16
  v_bfi_b32 v170, s78, v162, v161
  v_alignbit_b32 v174, v162, v162, 16
  v_bfi_b32 v178, s78, v163, v162
  v_alignbit_b32 v182, v163, v163, 16
  v_bfi_b32 v171, s78, v161, v160
  v_alignbit_b32 v175, v161, v161, 16
  v_bfi_b32 v179, s78, v162, v161
  v_alignbit_b32 v183, v162, v162, 16
  ds_write_b128 v61, v[168:171] offset:0
  ds_write_b128 v61, v[172:175] offset:2112
  ds_write_b128 v61, v[176:179] offset:4224
  ds_write_b128 v61, v[180:183] offset:6336
  s_add_u32 s66, s73, 3096
  v_sub_u32 v62, s66, v63
  ds_read_b64 v[160:161], v62
  ds_read_b128 v[162:165], v62 offset:8
  s_waitcnt lgkmcnt(0)
  v_bfi_b32 v168, s78, v164, v163
  v_alignbit_b32 v172, v164, v164, 16
  v_bfi_b32 v176, s78, v165, v164
  v_alignbit_b32 v180, v165, v165, 16
  v_bfi_b32 v169, s78, v163, v162
  v_alignbit_b32 v173, v163, v163, 16
  v_bfi_b32 v177, s78, v164, v163
  v_alignbit_b32 v181, v164, v164, 16
  v_bfi_b32 v170, s78, v162, v161
  v_alignbit_b32 v174, v162, v162, 16
  v_bfi_b32 v178, s78, v163, v162
  v_alignbit_b32 v182, v163, v163, 16
  v_bfi_b32 v171, s78, v161, v160
  v_alignbit_b32 v175, v161, v161, 16
  v_bfi_b32 v179, s78, v162, v161
  v_alignbit_b32 v183, v162, v162, 16
  ds_write_b128 v61, v[168:171] offset:1024
  ds_write_b128 v61, v[172:175] offset:3136
  ds_write_b128 v61, v[176:179] offset:5248
  ds_write_b128 v61, v[180:183] offset:7360
  s_mov_b32 exec_lo, 3
  s_mov_b32 exec_hi, 0
  s_add_u32 s66, s73, 2072
  v_sub_u32 v62, s66, v63
  ds_read_b64 v[160:161], v62
  ds_read_b128 v[162:165], v62 offset:8
  s_waitcnt lgkmcnt(0)
  v_bfi_b32 v168, s78, v164, v163
  v_alignbit_b32 v172, v164, v164, 16
  v_bfi_b32 v176, s78, v165, v164
  v_alignbit_b32 v180, v165, v165, 16
  v_bfi_b32 v169, s78, v163, v162
  v_alignbit_b32 v173, v163, v163, 16
  v_bfi_b32 v177, s78, v164, v163
  v_alignbit_b32 v181, v164, v164, 16
  v_bfi_b32 v170, s78, v162, v161
  v_alignbit_b32 v174, v162, v162, 16
  v_bfi_b32 v178, s78, v163, v162
  v_alignbit_b32 v182, v163, v163, 16
  v_bfi_b32 v171, s78, v161, v160
  v_alignbit_b32 v175, v161, v161, 16
  v_bfi_b32 v179, s78, v162, v161
  v_alignbit_b32 v183, v162, v162, 16
  ds_write_b128 v61, v[168:171] offset:2048
  ds_write_b128 v61, v[172:175] offset:4160
  ds_write_b128 v61, v[176:179] offset:6272
  ds_write_b128 v61, v[180:183] offset:8384
  s_mov_b64 exec, -1
  s_waitcnt lgkmcnt(0)
  ds_read_b64 v[64:65], v56 offset:2040
  ds_read_b64 v[66:67], v56 offset:2048
  ds_read_b64 v[68:69], v56 offset:1528
  ds_read_b64 v[70:71], v56 offset:1536
  ds_read_b64 v[72:73], v56 offset:1016
  ds_read_b64 v[74:75], v56 offset:1024
  ds_read_b64 v[76:77], v56 offset:504
  ds_read_b64 v[78:79], v56 offset:512
  ds_read_b128 v[96:99], v57 offset:1792
  ds_read_b128 v[100:103], v57 offset:3840
  ds_read_b128 v[104:107], v57 offset:5888
  ds_read_b128 v[108:111], v57 offset:7936
  s_waitcnt lgkmcnt(0)
  v_mfma_f32_16x16x32_bf16 v[40:43], v[64:67], v[96:99], v[40:43]
  ds_read_b64 v[80:81], v56 offset:1976
  ds_read_b64 v[82:83], v56 offset:1984
  v_mfma_f32_16x16x32_bf16 v[44:47], v[64:67], v[100:103], v[44:47]
  ds_read_b64 v[84:85], v56 offset:1464
  ds_read_b64 v[86:87], v56 offset:1472
  v_mfma_f32_16x16x32_bf16 v[48:51], v[64:67], v[104:107], v[48:51]
  ds_read_b64 v[88:89], v56 offset:952
  ds_read_b64 v[90:91], v56 offset:960
  v_mfma_f32_16x16x32_bf16 v[52:55], v[64:67], v[108:111], v[52:55]
  ds_read_b64 v[92:93], v56 offset:440
  ds_read_b64 v[94:95], v56 offset:448
  v_mfma_f32_16x16x32_bf16 v[44:47], v[68:71], v[96:99], v[44:47]
  ds_read_b128 v[128:131], v58 offset:1536
  ds_read_b128 v[132:135], v58 offset:3584
  v_mfma_f32_16x16x32_bf16 v[48:51], v[68:71], v[100:103], v[48:51]
  ds_read_b128 v[136:139], v58 offset:5632
  ds_read_b128 v[140:143], v58 offset:7680
  v_mfma_f32_16x16x32_bf16 v[52:55], v[68:71], v[104:107], v[52:55]
  v_mfma_f32_16x16x32_bf16 v[48:51], v[72:75], v[96:99], v[48:51]
  v_mfma_f32_16x16x32_bf16 v[52:55], v[72:75], v[100:103], v[52:55]
  v_mfma_f32_16x16x32_bf16 v[52:55], v[76:79], v[96:99], v[52:55]
  s_waitcnt lgkmcnt(0)
  v_mfma_f32_16x16x32_bf16 v[40:43], v[80:83], v[128:131], v[40:43]
  ds_read_b64 v[64:65], v56 offset:1912
  ds_read_b64 v[66:67], v56 offset:1920
  v_mfma_f32_16x16x32_bf16 v[44:47], v[80:83], v[132:135], v[44:47]
  ds_read_b64 v[68:69], v56 offset:1400
  ds_read_b64 v[70:71], v56 offset:1408
  v_mfma_f32_16x16x32_bf16 v[48:51], v[80:83], v[136:139], v[48:51]
  ds_read_b64 v[72:73], v56 offset:888
  ds_read_b64 v[74:75], v56 offset:896
  v_mfma_f32_16x16x32_bf16 v[52:55], v[80:83], v[140:143], v[52:55]
  ds_read_b64 v[76:77], v56 offset:376
  ds_read_b64 v[78:79], v56 offset:384
  v_mfma_f32_16x16x32_bf16 v[44:47], v[84:87], v[128:131], v[44:47]
  ds_read_b128 v[96:99], v59 offset:1280
  ds_read_b128 v[100:103], v59 offset:3328
  v_mfma_f32_16x16x32_bf16 v[48:51], v[84:87], v[132:135], v[48:51]
  ds_read_b128 v[104:107], v59 offset:5376
  ds_read_b128 v[108:111], v59 offset:7424
  v_mfma_f32_16x16x32_bf16 v[52:55], v[84:87], v[136:139], v[52:55]
  v_mfma_f32_16x16x32_bf16 v[48:51], v[88:91], v[128:131], v[48:51]
  v_mfma_f32_16x16x32_bf16 v[52:55], v[88:91], v[132:135], v[52:55]
  v_mfma_f32_16x16x32_bf16 v[52:55], v[92:95], v[128:131], v[52:55]
  s_waitcnt lgkmcnt(0)
  v_mfma_f32_16x16x32_bf16 v[40:43], v[64:67], v[96:99], v[40:43]
  ds_read_b64 v[80:81], v56 offset:1848
  ds_read_b64 v[82:83], v56 offset:1856
  v_mfma_f32_16x16x32_bf16 v[44:47], v[64:67], v[100:103], v[44:47]
  ds_read_b64 v[84:85], v56 offset:1336
  ds_read_b64 v[86:87], v56 offset:1344
  v_mfma_f32_16x16x32_bf16 v[48:51], v[64:67], v[104:107], v[48:51]
  ds_read_b64 v[88:89], v56 offset:824
  ds_read_b64 v[90:91], v56 offset:832
  v_mfma_f32_16x16x32_bf16 v[52:55], v[64:67], v[108:111], v[52:55]
  ds_read_b64 v[92:93], v56 offset:312
  ds_read_b64 v[94:95], v56 offset:320
  v_mfma_f32_16x16x32_bf16 v[44:47], v[68:71], v[96:99], v[44:47]
  ds_read_b128 v[128:131], v60 offset:1024
  ds_read_b128 v[132:135], v60 offset:3072
  v_mfma_f32_16x16x32_bf16 v[48:51], v[68:71], v[100:103], v[48:51]
  ds_read_b128 v[136:139], v60 offset:5120
  ds_read_b128 v[140:143], v60 offset:7168
  v_mfma_f32_16x16x32_bf16 v[52:55], v[68:71], v[104:107], v[52:55]
  v_mfma_f32_16x16x32_bf16 v[48:51], v[72:75], v[96:99], v[48:51]
  v_mfma_f32_16x16x32_bf16 v[52:55], v[72:75], v[100:103], v[52:55]
  v_mfma_f32_16x16x32_bf16 v[52:55], v[76:79], v[96:99], v[52:55]
  s_waitcnt lgkmcnt(0)
  v_mfma_f32_16x16x32_bf16 v[40:43], v[80:83], v[128:131], v[40:43]
  ds_read_b64 v[64:65], v56 offset:1784
  ds_read_b64 v[66:67], v56 offset:1792
  v_mfma_f32_16x16x32_bf16 v[44:47], v[80:83], v[132:135], v[44:47]
  ds_read_b64 v[68:69], v56 offset:1272
  ds_read_b64 v[70:71], v56 offset:1280
  v_mfma_f32_16x16x32_bf16 v[48:51], v[80:83], v[136:139], v[48:51]
  ds_read_b64 v[72:73], v56 offset:760
  ds_read_b64 v[74:75], v56 offset:768
  v_mfma_f32_16x16x32_bf16 v[52:55], v[80:83], v[140:143], v[52:55]
  ds_read_b64 v[76:77], v56 offset:248
  ds_read_b64 v[78:79], v56 offset:256
  v_mfma_f32_16x16x32_bf16 v[44:47], v[84:87], v[128:131], v[44:47]
  ds_read_b128 v[96:99], v57 offset:768
  ds_read_b128 v[100:103], v57 offset:2816
  v_mfma_f32_16x16x32_bf16 v[48:51], v[84:87], v[132:135], v[48:51]
  ds_read_b128 v[104:107], v57 offset:4864
  ds_read_b128 v[108:111], v57 offset:6912
  v_mfma_f32_16x16x32_bf16 v[52:55], v[84:87], v[136:139], v[52:55]
  v_mfma_f32_16x16x32_bf16 v[48:51], v[88:91], v[128:131], v[48:51]
  v_mfma_f32_16x16x32_bf16 v[52:55], v[88:91], v[132:135], v[52:55]
  v_mfma_f32_16x16x32_bf16 v[52:55], v[92:95], v[128:131], v[52:55]
  s_waitcnt lgkmcnt(0)
  v_mfma_f32_16x16x32_bf16 v[40:43], v[64:67], v[96:99], v[40:43]
  ds_read_b64 v[80:81], v56 offset:1720
  ds_read_b64 v[82:83], v56 offset:1728
  v_mfma_f32_16x16x32_bf16 v[44:47], v[64:67], v[100:103], v[44:47]
  ds_read_b64 v[84:85], v56 offset:1208
  ds_read_b64 v[86:87], v56 offset:1216
  v_mfma_f32_16x16x32_bf16 v[48:51], v[64:67], v[104:107], v[48:51]
  ds_read_b64 v[88:89], v56 offset:696
  ds_read_b64 v[90:91], v56 offset:704
  v_mfma_f32_16x16x32_bf16 v[52:55], v[64:67], v[108:111], v[52:55]
  ds_read_b64 v[92:93], v56 offset:184
  ds_read_b64 v[94:95], v56 offset:192
  v_mfma_f32_16x16x32_bf16 v[44:47], v[68:71], v[96:99], v[44:47]
  ds_read_b128 v[128:131], v58 offset:512
  ds_read_b128 v[132:135], v58 offset:2560
  v_mfma_f32_16x16x32_bf16 v[48:51], v[68:71], v[100:103], v[48:51]
  ds_read_b128 v[136:139], v58 offset:4608
  ds_read_b128 v[140:143], v58 offset:6656
  v_mfma_f32_16x16x32_bf16 v[52:55], v[68:71], v[104:107], v[52:55]
  v_mfma_f32_16x16x32_bf16 v[48:51], v[72:75], v[96:99], v[48:51]
  v_mfma_f32_16x16x32_bf16 v[52:55], v[72:75], v[100:103], v[52:55]
  v_mfma_f32_16x16x32_bf16 v[52:55], v[76:79], v[96:99], v[52:55]
  s_waitcnt lgkmcnt(0)
  v_mfma_f32_16x16x32_bf16 v[40:43], v[80:83], v[128:131], v[40:43]
  ds_read_b64 v[64:65], v56 offset:1656
  ds_read_b64 v[66:67], v56 offset:1664
  v_mfma_f32_16x16x32_bf16 v[44:47], v[80:83], v[132:135], v[44:47]
  ds_read_b64 v[68:69], v56 offset:1144
  ds_read_b64 v[70:71], v56 offset:1152
  v_mfma_f32_16x16x32_bf16 v[48:51], v[80:83], v[136:139], v[48:51]
  ds_read_b64 v[72:73], v56 offset:632
  ds_read_b64 v[74:75], v56 offset:640
  v_mfma_f32_16x16x32_bf16 v[52:55], v[80:83], v[140:143], v[52:55]
  ds_read_b64 v[76:77], v56 offset:120
  ds_read_b64 v[78:79], v56 offset:128
  v_mfma_f32_16x16x32_bf16 v[44:47], v[84:87], v[128:131], v[44:47]
  ds_read_b128 v[96:99], v59 offset:256
  ds_read_b128 v[100:103], v59 offset:2304
  v_mfma_f32_16x16x32_bf16 v[48:51], v[84:87], v[132:135], v[48:51]
  ds_read_b128 v[104:107], v59 offset:4352
  ds_read_b128 v[108:111], v59 offset:6400
  v_mfma_f32_16x16x32_bf16 v[52:55], v[84:87], v[136:139], v[52:55]
  v_mfma_f32_16x16x32_bf16 v[48:51], v[88:91], v[128:131], v[48:51]
  v_mfma_f32_16x16x32_bf16 v[52:55], v[88:91], v[132:135], v[52:55]
  v_mfma_f32_16x16x32_bf16 v[52:55], v[92:95], v[128:131], v[52:55]
  s_waitcnt lgkmcnt(0)
  v_mfma_f32_16x16x32_bf16 v[40:43], v[64:67], v[96:99], v[40:43]
  ds_read_b64 v[80:81], v56 offset:1592
  ds_read_b64 v[82:83], v56 offset:1600
  v_mfma_f32_16x16x32_bf16 v[44:47], v[64:67], v[100:103], v[44:47]
  ds_read_b64 v[84:85], v56 offset:1080
  ds_read_b64 v[86:87], v56 offset:1088
  v_mfma_f32_16x16x32_bf16 v[48:51], v[64:67], v[104:107], v[48:51]
  ds_read_b64 v[88:89], v56 offset:568
  ds_read_b64 v[90:91], v56 offset:576
  v_mfma_f32_16x16x32_bf16 v[52:55], v[64:67], v[108:111], v[52:55]
  ds_read_b64 v[92:93], v56 offset:56
  ds_read_b64 v[94:95], v56 offset:64
  v_mfma_f32_16x16x32_bf16 v[44:47], v[68:71], v[96:99], v[44:47]
  ds_read_b128 v[128:131], v60 offset:0
  ds_read_b128 v[132:135], v60 offset:2048
  v_mfma_f32_16x16x32_bf16 v[48:51], v[68:71], v[100:103], v[48:51]
  ds_read_b128 v[136:139], v60 offset:4096
  ds_read_b128 v[140:143], v60 offset:6144
  v_mfma_f32_16x16x32_bf16 v[52:55], v[68:71], v[104:107], v[52:55]
  v_mfma_f32_16x16x32_bf16 v[48:51], v[72:75], v[96:99], v[48:51]
  v_mfma_f32_16x16x32_bf16 v[52:55], v[72:75], v[100:103], v[52:55]
  v_mfma_f32_16x16x32_bf16 v[52:55], v[76:79], v[96:99], v[52:55]
  s_waitcnt lgkmcnt(0)
  v_mfma_f32_16x16x32_bf16 v[40:43], v[80:83], v[128:131], v[40:43]
  v_mfma_f32_16x16x32_bf16 v[44:47], v[80:83], v[132:135], v[44:47]
  v_mfma_f32_16x16x32_bf16 v[48:51], v[80:83], v[136:139], v[48:51]
  v_mfma_f32_16x16x32_bf16 v[52:55], v[80:83], v[140:143], v[52:55]
  v_mfma_f32_16x16x32_bf16 v[44:47], v[84:87], v[128:131], v[44:47]
  v_mfma_f32_16x16x32_bf16 v[48:51], v[84:87], v[132:135], v[48:51]
  v_mfma_f32_16x16x32_bf16 v[52:55], v[84:87], v[136:139], v[52:55]
  v_mfma_f32_16x16x32_bf16 v[48:51], v[88:91], v[128:131], v[48:51]
  v_mfma_f32_16x16x32_bf16 v[52:55], v[88:91], v[132:135], v[52:55]
  v_mfma_f32_16x16x32_bf16 v[52:55], v[92:95], v[128:131], v[52:55]
  s_setprio 3
  v_and_b32 v2, 15, v1
  v_lshlrev_b32 v2, 1, v2
  v_lshrrev_b32 v3, 5, v1
  v_add_u32 v2, v2, v3
  v_bfe_u32 v3, v2, 2, 2
  v_xor_b32 v3, s64, v3
  v_lshlrev_b32 v3, 4, v3
  v_lshl_add_u32 v186, v2, 6, v3
  v_bfe_u32 v3, v1, 4, 1
  v_lshl_add_u32 v186, v3, 3, v186
  v_add_u32 v186, 6464, v186
  v_and_b32 v2, 15, v1
  v_lshlrev_b32 v187, 5, v2
  v_lshrrev_b32 v3, 4, v1
  v_lshl_add_u32 v187, v3, 3, v187
  s_lshl_b32 s66, s65, 12
  s_add_u32 s66, s66, 11534336
  v_add_u32 v187, s66, v187
  v_mov_b32 v188, s69
  v_mov_b32 v189, s69
  ds_read_b64 v[64:65], v186 offset:0
  ds_read_b64 v[66:67], v186 offset:2048
  ds_read_b64 v[68:69], v186 offset:4096
  ds_read_b64 v[70:71], v186 offset:6144
  ds_read_b64 v[72:73], v186 offset:8192
  ds_read_b64 v[74:75], v186 offset:10240
  ds_read_b64 v[76:77], v186 offset:12288
  ds_read_b64 v[78:79], v186 offset:14336
  s_waitcnt lgkmcnt(7)
  v_lshlrev_b32 v96, 16, v64
  v_and_b32 v97, 0xffff0000, v64
  v_lshlrev_b32 v98, 16, v65
  v_and_b32 v99, 0xffff0000, v65
  v_mul_f32 v96, v96, v188
  v_mul_f32 v97, v97, v188
  v_mul_f32 v98, v98, v188
  v_mul_f32 v99, v99, v188
  v_cvt_pk_bf16_f32 v100, v96, v97
  v_cvt_pk_bf16_f32 v101, v98, v99
  v_cvt_pk_bf16_f32 v102, v24, v25
  v_cvt_pk_bf16_f32 v103, v26, v27
  v_lshlrev_b32 v96, 16, v100
  v_and_b32 v97, 0xffff0000, v100
  v_lshlrev_b32 v98, 16, v102
  v_and_b32 v99, 0xffff0000, v102
  v_add_f32 v96, v96, v98
  v_add_f32 v97, v97, v99
  v_cvt_pk_bf16_f32 v112, v96, v97
  v_lshlrev_b32 v96, 16, v101
  v_and_b32 v97, 0xffff0000, v101
  v_lshlrev_b32 v98, 16, v103
  v_and_b32 v99, 0xffff0000, v103
  v_add_f32 v96, v96, v98
  v_add_f32 v97, v97, v99
  v_cvt_pk_bf16_f32 v113, v96, v97
  buffer_store_dwordx2 v[112:113], v187, s[32:35], 0 offen offset:0 sc1
  s_waitcnt lgkmcnt(6)
  v_lshlrev_b32 v96, 16, v66
  v_and_b32 v97, 0xffff0000, v66
  v_lshlrev_b32 v98, 16, v67
  v_and_b32 v99, 0xffff0000, v67
  v_mul_f32 v96, v96, v188
  v_mul_f32 v97, v97, v188
  v_mul_f32 v98, v98, v188
  v_mul_f32 v99, v99, v188
  v_cvt_pk_bf16_f32 v100, v96, v97
  v_cvt_pk_bf16_f32 v101, v98, v99
  v_cvt_pk_bf16_f32 v102, v28, v29
  v_cvt_pk_bf16_f32 v103, v30, v31
  v_lshlrev_b32 v96, 16, v100
  v_and_b32 v97, 0xffff0000, v100
  v_lshlrev_b32 v98, 16, v102
  v_and_b32 v99, 0xffff0000, v102
  v_add_f32 v96, v96, v98
  v_add_f32 v97, v97, v99
  v_cvt_pk_bf16_f32 v114, v96, v97
  v_lshlrev_b32 v96, 16, v101
  v_and_b32 v97, 0xffff0000, v101
  v_lshlrev_b32 v98, 16, v103
  v_and_b32 v99, 0xffff0000, v103
  v_add_f32 v96, v96, v98
  v_add_f32 v97, v97, v99
  v_cvt_pk_bf16_f32 v115, v96, v97
  buffer_store_dwordx2 v[114:115], v187, s[32:35], 0 offen offset:512 sc1
  s_waitcnt lgkmcnt(5)
  v_lshlrev_b32 v96, 16, v68
  v_and_b32 v97, 0xffff0000, v68
  v_lshlrev_b32 v98, 16, v69
  v_and_b32 v99, 0xffff0000, v69
  v_mul_f32 v96, v96, v188
  v_mul_f32 v97, v97, v188
  v_mul_f32 v98, v98, v188
  v_mul_f32 v99, v99, v188
  v_cvt_pk_bf16_f32 v100, v96, v97
  v_cvt_pk_bf16_f32 v101, v98, v99
  v_cvt_pk_bf16_f32 v102, v32, v33
  v_cvt_pk_bf16_f32 v103, v34, v35
  v_lshlrev_b32 v96, 16, v100
  v_and_b32 v97, 0xffff0000, v100
  v_lshlrev_b32 v98, 16, v102
  v_and_b32 v99, 0xffff0000, v102
  v_add_f32 v96, v96, v98
  v_add_f32 v97, v97, v99
  v_cvt_pk_bf16_f32 v112, v96, v97
  v_lshlrev_b32 v96, 16, v101
  v_and_b32 v97, 0xffff0000, v101
  v_lshlrev_b32 v98, 16, v103
  v_and_b32 v99, 0xffff0000, v103
  v_add_f32 v96, v96, v98
  v_add_f32 v97, v97, v99
  v_cvt_pk_bf16_f32 v113, v96, v97
  buffer_store_dwordx2 v[112:113], v187, s[32:35], 0 offen offset:1024 sc1
  s_waitcnt lgkmcnt(4)
  v_lshlrev_b32 v96, 16, v70
  v_and_b32 v97, 0xffff0000, v70
  v_lshlrev_b32 v98, 16, v71
  v_and_b32 v99, 0xffff0000, v71
  v_mul_f32 v96, v96, v188
  v_mul_f32 v97, v97, v188
  v_mul_f32 v98, v98, v188
  v_mul_f32 v99, v99, v188
  v_cvt_pk_bf16_f32 v100, v96, v97
  v_cvt_pk_bf16_f32 v101, v98, v99
  v_cvt_pk_bf16_f32 v102, v36, v37
  v_cvt_pk_bf16_f32 v103, v38, v39
  v_lshlrev_b32 v96, 16, v100
  v_and_b32 v97, 0xffff0000, v100
  v_lshlrev_b32 v98, 16, v102
  v_and_b32 v99, 0xffff0000, v102
  v_add_f32 v96, v96, v98
  v_add_f32 v97, v97, v99
  v_cvt_pk_bf16_f32 v114, v96, v97
  v_lshlrev_b32 v96, 16, v101
  v_and_b32 v97, 0xffff0000, v101
  v_lshlrev_b32 v98, 16, v103
  v_and_b32 v99, 0xffff0000, v103
  v_add_f32 v96, v96, v98
  v_add_f32 v97, v97, v99
  v_cvt_pk_bf16_f32 v115, v96, v97
  buffer_store_dwordx2 v[114:115], v187, s[32:35], 0 offen offset:1536 sc1
  s_waitcnt lgkmcnt(3)
  v_lshlrev_b32 v96, 16, v72
  v_and_b32 v97, 0xffff0000, v72
  v_lshlrev_b32 v98, 16, v73
  v_and_b32 v99, 0xffff0000, v73
  v_mul_f32 v96, v96, v188
  v_mul_f32 v97, v97, v188
  v_mul_f32 v98, v98, v188
  v_mul_f32 v99, v99, v188
  v_cvt_pk_bf16_f32 v100, v96, v97
  v_cvt_pk_bf16_f32 v101, v98, v99
  v_cvt_pk_bf16_f32 v102, v40, v41
  v_cvt_pk_bf16_f32 v103, v42, v43
  v_lshlrev_b32 v96, 16, v100
  v_and_b32 v97, 0xffff0000, v100
  v_lshlrev_b32 v98, 16, v102
  v_and_b32 v99, 0xffff0000, v102
  v_add_f32 v96, v96, v98
  v_add_f32 v97, v97, v99
  v_cvt_pk_bf16_f32 v112, v96, v97
  v_lshlrev_b32 v96, 16, v101
  v_and_b32 v97, 0xffff0000, v101
  v_lshlrev_b32 v98, 16, v103
  v_and_b32 v99, 0xffff0000, v103
  v_add_f32 v96, v96, v98
  v_add_f32 v97, v97, v99
  v_cvt_pk_bf16_f32 v113, v96, v97
  buffer_store_dwordx2 v[112:113], v187, s[32:35], 0 offen offset:2048 sc1
  s_waitcnt lgkmcnt(2)
  v_lshlrev_b32 v96, 16, v74
  v_and_b32 v97, 0xffff0000, v74
  v_lshlrev_b32 v98, 16, v75
  v_and_b32 v99, 0xffff0000, v75
  v_mul_f32 v96, v96, v188
  v_mul_f32 v97, v97, v188
  v_mul_f32 v98, v98, v188
  v_mul_f32 v99, v99, v188
  v_cvt_pk_bf16_f32 v100, v96, v97
  v_cvt_pk_bf16_f32 v101, v98, v99
  v_cvt_pk_bf16_f32 v102, v44, v45
  v_cvt_pk_bf16_f32 v103, v46, v47
  v_lshlrev_b32 v96, 16, v100
  v_and_b32 v97, 0xffff0000, v100
  v_lshlrev_b32 v98, 16, v102
  v_and_b32 v99, 0xffff0000, v102
  v_add_f32 v96, v96, v98
  v_add_f32 v97, v97, v99
  v_cvt_pk_bf16_f32 v114, v96, v97
  v_lshlrev_b32 v96, 16, v101
  v_and_b32 v97, 0xffff0000, v101
  v_lshlrev_b32 v98, 16, v103
  v_and_b32 v99, 0xffff0000, v103
  v_add_f32 v96, v96, v98
  v_add_f32 v97, v97, v99
  v_cvt_pk_bf16_f32 v115, v96, v97
  buffer_store_dwordx2 v[114:115], v187, s[32:35], 0 offen offset:2560 sc1
  s_waitcnt lgkmcnt(1)
  v_lshlrev_b32 v96, 16, v76
  v_and_b32 v97, 0xffff0000, v76
  v_lshlrev_b32 v98, 16, v77
  v_and_b32 v99, 0xffff0000, v77
  v_mul_f32 v96, v96, v188
  v_mul_f32 v97, v97, v188
  v_mul_f32 v98, v98, v188
  v_mul_f32 v99, v99, v188
  v_cvt_pk_bf16_f32 v100, v96, v97
  v_cvt_pk_bf16_f32 v101, v98, v99
  v_cvt_pk_bf16_f32 v102, v48, v49
  v_cvt_pk_bf16_f32 v103, v50, v51
  v_lshlrev_b32 v96, 16, v100
  v_and_b32 v97, 0xffff0000, v100
  v_lshlrev_b32 v98, 16, v102
  v_and_b32 v99, 0xffff0000, v102
  v_add_f32 v96, v96, v98
  v_add_f32 v97, v97, v99
  v_cvt_pk_bf16_f32 v112, v96, v97
  v_lshlrev_b32 v96, 16, v101
  v_and_b32 v97, 0xffff0000, v101
  v_lshlrev_b32 v98, 16, v103
  v_and_b32 v99, 0xffff0000, v103
  v_add_f32 v96, v96, v98
  v_add_f32 v97, v97, v99
  v_cvt_pk_bf16_f32 v113, v96, v97
  buffer_store_dwordx2 v[112:113], v187, s[32:35], 0 offen offset:3072 sc1
  s_waitcnt lgkmcnt(0)
  v_lshlrev_b32 v96, 16, v78
  v_and_b32 v97, 0xffff0000, v78
  v_lshlrev_b32 v98, 16, v79
  v_and_b32 v99, 0xffff0000, v79
  v_mul_f32 v96, v96, v188
  v_mul_f32 v97, v97, v188
  v_mul_f32 v98, v98, v188
  v_mul_f32 v99, v99, v188
  v_cvt_pk_bf16_f32 v100, v96, v97
  v_cvt_pk_bf16_f32 v101, v98, v99
  v_cvt_pk_bf16_f32 v102, v52, v53
  v_cvt_pk_bf16_f32 v103, v54, v55
  v_lshlrev_b32 v96, 16, v100
  v_and_b32 v97, 0xffff0000, v100
  v_lshlrev_b32 v98, 16, v102
  v_and_b32 v99, 0xffff0000, v102
  v_add_f32 v96, v96, v98
  v_add_f32 v97, v97, v99
  v_cvt_pk_bf16_f32 v114, v96, v97
  v_lshlrev_b32 v96, 16, v101
  v_and_b32 v97, 0xffff0000, v101
  v_lshlrev_b32 v98, 16, v103
  v_and_b32 v99, 0xffff0000, v103
  v_add_f32 v96, v96, v98
  v_add_f32 v97, v97, v99
  v_cvt_pk_bf16_f32 v115, v96, v97
  buffer_store_dwordx2 v[114:115], v187, s[32:35], 0 offen offset:3584 sc1
  s_waitcnt vmcnt(0)
  s_barrier
  s_lshl_b32 s66, s46, 6
  s_add_u32 s66, s66, 14745600
  v_cmp_eq_u32 vcc, 0, v0
  s_nop 3
  s_and_saveexec_b64 s[42:43], vcc
  s_cbranch_execz Lfs_66
  v_mov_b32 v2, 0
  v_mov_b32 v3, s40
  buffer_store_dword v3, v2, s[32:35], s66 offen sc1
Lfs_66:
  s_mov_b64 exec, s[42:43]
  s_endpgm
Laux:
  s_setprio 3
  s_sub_u32 s46, s2, 416
  v_and_b32 v1, 63, v0
  v_lshrrev_b32 v2, 6, v0
  s_waitcnt lgkmcnt(0)
  s_mov_b32 s32, s30
  s_and_b32 s33, s31, 0xffff
  s_mov_b32 s34, 0x1000000
  s_mov_b32 s35, 0x20000
  s_mov_b32 s36, s4
  s_and_b32 s37, s5, 0xffff
  s_mov_b32 s38, 0x280000
  s_mov_b32 s39, 0x20000
  s_and_b32 s50, s46, 7
  s_lshl_b32 s50, s50, 4
  s_lshr_b32 s48, s46, 3
  s_add_u32 s50, s50, s48
  s_add_u32 s51, s50, 12
  v_lshrrev_b32 v4, 4, v1
  v_lshl_add_u32 v4, v2, 2, v4
  s_lshl_b32 s48, s50, 4
  v_add_u32 v4, s48, v4
  v_mul_u32_u24 v3, 1280, v4
  v_and_b32 v5, 15, v1
  v_lshl_add_u32 v3, v5, 4, v3
  buffer_load_dwordx4 v[16:19], v3, s[36:39], 0 offen offset:0
  buffer_load_dwordx4 v[20:23], v3, s[36:39], 0 offen offset:256
  buffer_load_dwordx4 v[24:27], v3, s[36:39], 0 offen offset:512
  buffer_load_dwordx4 v[28:31], v3, s[36:39], 0 offen offset:768
  buffer_load_dwordx4 v[32:35], v3, s[36:39], 0 offen offset:1024
  s_cmp_ge_u32 s46, 32
  s_cbranch_scc1 Lax_67
  v_lshrrev_b32 v4, 4, v1
  v_lshl_add_u32 v4, v2, 2, v4
  s_lshl_b32 s48, s51, 4
  v_add_u32 v4, s48, v4
  v_mul_u32_u24 v3, 1280, v4
  v_and_b32 v5, 15, v1
  v_lshl_add_u32 v3, v5, 4, v3
  buffer_load_dwordx4 v[36:39], v3, s[36:39], 0 offen offset:0
  buffer_load_dwordx4 v[40:43], v3, s[36:39], 0 offen offset:256
  buffer_load_dwordx4 v[44:47], v3, s[36:39], 0 offen offset:512
  buffer_load_dwordx4 v[48:51], v3, s[36:39], 0 offen offset:768
  buffer_load_dwordx4 v[52:55], v3, s[36:39], 0 offen offset:1024
Lax_67:
  v_readfirstlane_b32 s47, v2
  s_mov_b32 s56, s24
  s_and_b32 s57, s25, 0xffff
  s_mov_b32 s58, 0x1e0000
  s_mov_b32 s59, 0x20000
  s_lshl_b32 s60, s46, 2
  s_add_u32 s60, s60, s47
  s_add_u32 s61, s60, 96
  s_lshl_b32 s62, s47, 12
  s_add_u32 s63, s62, 40960
  v_mov_b32 v254, 14286848
  buffer_load_dword v254, v254, s[32:35], 0 offen sc1
  s_setprio 3
  v_lshrrev_b32 v4, 4, v1
  v_lshl_add_u32 v4, v2, 2, v4
  v_mul_u32_u24 v10, 1344, v4
  v_and_b32 v5, 15, v1
  v_lshl_add_u32 v10, v5, 4, v10
  v_add_u32 v10, 16384, v10
  v_bfe_u32 v4, v1, 2, 2
  v_mul_u32_u24 v11, 1344, v4
  v_lshrrev_b32 v4, 4, v1
  v_lshl_add_u32 v11, v4, 5, v11
  v_and_b32 v5, 3, v1
  v_lshl_add_u32 v11, v5, 3, v11
  s_lshr_b32 s48, s47, 1
  s_mul_i32 s48, s48, 10752
  s_and_b32 s49, s47, 1
  s_mul_i32 s49, s49, 640
  s_add_u32 s48, s48, s49
  s_add_u32 s48, s48, 16384
  v_add_u32 v11, s48, v11
  v_bfe_u32 v5, v1, 3, 1
  v_lshl_add_u32 v5, v4, 1, v5
  v_lshlrev_b32 v12, 15, v5
  v_and_b32 v5, 7, v1
  v_lshl_add_u32 v12, v5, 4, v12
  s_lshr_b32 s48, s47, 1
  s_lshl_b32 s48, s48, 7
  s_and_b32 s49, s47, 1
  s_mul_i32 s49, s49, 1310720
  s_add_u32 s48, s48, s49
  v_add_u32 v12, s48, v12
  s_waitcnt vmcnt(0) lgkmcnt(0)
  v_readfirstlane_b32 s40, v254
  s_nop 3
  s_add_u32 s40, s40, 0x9e3779b1
  s_mul_i32 s64, s60, 6554
  s_lshr_b32 s64, s64, 16
  s_mul_i32 s66, s64, 10
  s_sub_u32 s65, s60, s66
  v_lshrrev_b32 v4, 3, v1
  v_mul_u32_u24 v60, 1280, v4
  v_and_b32 v5, 7, v1
  v_lshl_add_u32 v60, v5, 4, v60
  s_mul_i32 s66, s64, 40960
  s_lshl_b32 s67, s65, 7
  s_add_u32 s66, s66, s67
  s_add_u32 m0, s62, 0
  s_nop 0
  buffer_load_dwordx4 v60, s[56:59], s66 offen lds
  s_add_u32 s66, s66, 10240
  s_add_u32 m0, s62, 1024
  s_nop 0
  buffer_load_dwordx4 v60, s[56:59], s66 offen lds
  s_add_u32 s66, s66, 10240
  s_add_u32 m0, s62, 2048
  s_nop 0
  buffer_load_dwordx4 v60, s[56:59], s66 offen lds
  s_add_u32 s66, s66, 10240
  s_add_u32 m0, s62, 3072
  s_nop 0
  buffer_load_dwordx4 v60, s[56:59], s66 offen lds
  s_cmp_lt_u32 s60, 288
  s_cbranch_scc1 Lax_68
  s_mul_i32 s68, s61, 6554
  s_lshr_b32 s68, s68, 16
  s_mul_i32 s70, s68, 10
  s_sub_u32 s69, s61, s70
  v_lshrrev_b32 v4, 3, v1
  v_mul_u32_u24 v60, 1280, v4
  v_and_b32 v5, 7, v1
  v_lshl_add_u32 v60, v5, 4, v60
  s_mul_i32 s70, s68, 40960
  s_lshl_b32 s71, s69, 7
  s_add_u32 s70, s70, s71
  s_add_u32 m0, s63, 0
  s_nop 0
  buffer_load_dwordx4 v60, s[56:59], s70 offen lds
  s_add_u32 s70, s70, 10240
  s_add_u32 m0, s63, 1024
  s_nop 0
  buffer_load_dwordx4 v60, s[56:59], s70 offen lds
  s_add_u32 s70, s70, 10240
  s_add_u32 m0, s63, 2048
  s_nop 0
  buffer_load_dwordx4 v60, s[56:59], s70 offen lds
  s_add_u32 s70, s70, 10240
  s_add_u32 m0, s63, 3072
  s_nop 0
  buffer_load_dwordx4 v60, s[56:59], s70 offen lds
Lax_68:
  v_lshlrev_b32 v100, 16, v16
  v_and_b32 v101, 0xffff0000, v16
  v_lshlrev_b32 v102, 16, v17
  v_and_b32 v103, 0xffff0000, v17
  v_lshlrev_b32 v104, 16, v18
  v_and_b32 v105, 0xffff0000, v18
  v_lshlrev_b32 v106, 16, v19
  v_and_b32 v107, 0xffff0000, v19
  v_lshlrev_b32 v108, 16, v20
  v_and_b32 v109, 0xffff0000, v20
  v_lshlrev_b32 v110, 16, v21
  v_and_b32 v111, 0xffff0000, v21
  v_lshlrev_b32 v112, 16, v22
  v_and_b32 v113, 0xffff0000, v22
  v_lshlrev_b32 v114, 16, v23
  v_and_b32 v115, 0xffff0000, v23
  v_lshlrev_b32 v116, 16, v24
  v_and_b32 v117, 0xffff0000, v24
  v_lshlrev_b32 v118, 16, v25
  v_and_b32 v119, 0xffff0000, v25
  v_lshlrev_b32 v120, 16, v26
  v_and_b32 v121, 0xffff0000, v26
  v_lshlrev_b32 v122, 16, v27
  v_and_b32 v123, 0xffff0000, v27
  v_lshlrev_b32 v124, 16, v28
  v_and_b32 v125, 0xffff0000, v28
  v_lshlrev_b32 v126, 16, v29
  v_and_b32 v127, 0xffff0000, v29
  v_lshlrev_b32 v128, 16, v30
  v_and_b32 v129, 0xffff0000, v30
  v_lshlrev_b32 v130, 16, v31
  v_and_b32 v131, 0xffff0000, v31
  v_lshlrev_b32 v132, 16, v32
  v_and_b32 v133, 0xffff0000, v32
  v_lshlrev_b32 v134, 16, v33
  v_and_b32 v135, 0xffff0000, v33
  v_lshlrev_b32 v136, 16, v34
  v_and_b32 v137, 0xffff0000, v34
  v_lshlrev_b32 v138, 16, v35
  v_and_b32 v139, 0xffff0000, v35
  v_add_f32 v8, v100, v102
  v_add_f32 v9, v101, v103
  v_add_f32 v8, v8, v104
  v_add_f32 v9, v9, v105
  v_add_f32 v8, v8, v106
  v_add_f32 v9, v9, v107
  v_add_f32 v8, v8, v108
  v_add_f32 v9, v9, v109
  v_add_f32 v8, v8, v110
  v_add_f32 v9, v9, v111
  v_add_f32 v8, v8, v112
  v_add_f32 v9, v9, v113
  v_add_f32 v8, v8, v114
  v_add_f32 v9, v9, v115
  v_add_f32 v8, v8, v116
  v_add_f32 v9, v9, v117
  v_add_f32 v8, v8, v118
  v_add_f32 v9, v9, v119
  v_add_f32 v8, v8, v120
  v_add_f32 v9, v9, v121
  v_add_f32 v8, v8, v122
  v_add_f32 v9, v9, v123
  v_add_f32 v8, v8, v124
  v_add_f32 v9, v9, v125
  v_add_f32 v8, v8, v126
  v_add_f32 v9, v9, v127
  v_add_f32 v8, v8, v128
  v_add_f32 v9, v9, v129
  v_add_f32 v8, v8, v130
  v_add_f32 v9, v9, v131
  v_add_f32 v8, v8, v132
  v_add_f32 v9, v9, v133
  v_add_f32 v8, v8, v134
  v_add_f32 v9, v9, v135
  v_add_f32 v8, v8, v136
  v_add_f32 v9, v9, v137
  v_add_f32 v8, v8, v138
  v_add_f32 v9, v9, v139
  v_add_f32 v6, v8, v9
  s_nop 1
  v_add_f32_dpp v6, v6, v6 row_ror:8 row_mask:0xf bank_mask:0xf
  s_nop 1
  v_add_f32_dpp v6, v6, v6 row_ror:4 row_mask:0xf bank_mask:0xf
  s_nop 1
  v_add_f32_dpp v6, v6, v6 row_ror:2 row_mask:0xf bank_mask:0xf
  s_nop 1
  v_add_f32_dpp v6, v6, v6 row_ror:1 row_mask:0xf bank_mask:0xf
  v_mul_f32 v6, 0x3acccccd, v6
  v_sub_f32 v100, v100, v6
  v_sub_f32 v101, v101, v6
  v_sub_f32 v102, v102, v6
  v_sub_f32 v103, v103, v6
  v_sub_f32 v104, v104, v6
  v_sub_f32 v105, v105, v6
  v_sub_f32 v106, v106, v6
  v_sub_f32 v107, v107, v6
  v_sub_f32 v108, v108, v6
  v_sub_f32 v109, v109, v6
  v_sub_f32 v110, v110, v6
  v_sub_f32 v111, v111, v6
  v_sub_f32 v112, v112, v6
  v_sub_f32 v113, v113, v6
  v_sub_f32 v114, v114, v6
  v_sub_f32 v115, v115, v6
  v_sub_f32 v116, v116, v6
  v_sub_f32 v117, v117, v6
  v_sub_f32 v118, v118, v6
  v_sub_f32 v119, v119, v6
  v_sub_f32 v120, v120, v6
  v_sub_f32 v121, v121, v6
  v_sub_f32 v122, v122, v6
  v_sub_f32 v123, v123, v6
  v_sub_f32 v124, v124, v6
  v_sub_f32 v125, v125, v6
  v_sub_f32 v126, v126, v6
  v_sub_f32 v127, v127, v6
  v_sub_f32 v128, v128, v6
  v_sub_f32 v129, v129, v6
  v_sub_f32 v130, v130, v6
  v_sub_f32 v131, v131, v6
  v_sub_f32 v132, v132, v6
  v_sub_f32 v133, v133, v6
  v_sub_f32 v134, v134, v6
  v_sub_f32 v135, v135, v6
  v_sub_f32 v136, v136, v6
  v_sub_f32 v137, v137, v6
  v_sub_f32 v138, v138, v6
  v_sub_f32 v139, v139, v6
  v_mul_f32 v8, v100, v100
  v_mul_f32 v9, v101, v101
  v_fmac_f32 v8, v102, v102
  v_fmac_f32 v9, v103, v103
  v_fmac_f32 v8, v104, v104
  v_fmac_f32 v9, v105, v105
  v_fmac_f32 v8, v106, v106
  v_fmac_f32 v9, v107, v107
  v_fmac_f32 v8, v108, v108
  v_fmac_f32 v9, v109, v109
  v_fmac_f32 v8, v110, v110
  v_fmac_f32 v9, v111, v111
  v_fmac_f32 v8, v112, v112
  v_fmac_f32 v9, v113, v113
  v_fmac_f32 v8, v114, v114
  v_fmac_f32 v9, v115, v115
  v_fmac_f32 v8, v116, v116
  v_fmac_f32 v9, v117, v117
  v_fmac_f32 v8, v118, v118
  v_fmac_f32 v9, v119, v119
  v_fmac_f32 v8, v120, v120
  v_fmac_f32 v9, v121, v121
  v_fmac_f32 v8, v122, v122
  v_fmac_f32 v9, v123, v123
  v_fmac_f32 v8, v124, v124
  v_fmac_f32 v9, v125, v125
  v_fmac_f32 v8, v126, v126
  v_fmac_f32 v9, v127, v127
  v_fmac_f32 v8, v128, v128
  v_fmac_f32 v9, v129, v129
  v_fmac_f32 v8, v130, v130
  v_fmac_f32 v9, v131, v131
  v_fmac_f32 v8, v132, v132
  v_fmac_f32 v9, v133, v133
  v_fmac_f32 v8, v134, v134
  v_fmac_f32 v9, v135, v135
  v_fmac_f32 v8, v136, v136
  v_fmac_f32 v9, v137, v137
  v_fmac_f32 v8, v138, v138
  v_fmac_f32 v9, v139, v139
  v_add_f32 v7, v8, v9
  s_nop 1
  v_add_f32_dpp v7, v7, v7 row_ror:8 row_mask:0xf bank_mask:0xf
  s_nop 1
  v_add_f32_dpp v7, v7, v7 row_ror:4 row_mask:0xf bank_mask:0xf
  s_nop 1
  v_add_f32_dpp v7, v7, v7 row_ror:2 row_mask:0xf bank_mask:0xf
  s_nop 1
  v_add_f32_dpp v7, v7, v7 row_ror:1 row_mask:0xf bank_mask:0xf
  v_mul_f32 v7, 0x3acccccd, v7
  v_cvt_pk_bf16_f32 v7, v7, v7
  v_and_b32 v7, 0xffff0000, v7
  v_add_f32 v7, 0x3727c5ac, v7
  v_cvt_pk_bf16_f32 v7, v7, v7
  v_and_b32 v7, 0xffff0000, v7
  v_sqrt_f32 v7, v7
  s_nop 0
  v_cvt_pk_bf16_f32 v7, v7, v7
  v_and_b32 v7, 0xffff0000, v7
  v_rcp_f32 v7, v7
  v_cvt_pk_bf16_f32 v160, v6, v6
  v_and_b32 v160, 0xffff0000, v160
  v_xor_b32 v160, 0x80000000, v160
  v_mov_b32 v161, v7
  v_mov_b32 v162, s40
  v_mov_b32 v163, s40
  v_lshrrev_b32 v4, 4, v1
  v_lshl_add_u32 v4, v2, 2, v4
  v_lshlrev_b32 v13, 4, v4
  s_lshl_b32 s48, s50, 8
  s_add_u32 s48, s48, 14155776
  s_mov_b32 exec_lo, 0x00010001
  s_mov_b32 exec_hi, 0x00010001
  buffer_store_dwordx4 v[160:163], v13, s[32:35], s48 offen sc1
  s_mov_b64 exec, -1
  v_mul_f32 v100, v100, v7
  v_mul_f32 v101, v101, v7
  v_mul_f32 v102, v102, v7
  v_mul_f32 v103, v103, v7
  v_mul_f32 v104, v104, v7
  v_mul_f32 v105, v105, v7
  v_mul_f32 v106, v106, v7
  v_mul_f32 v107, v107, v7
  v_mul_f32 v108, v108, v7
  v_mul_f32 v109, v109, v7
  v_mul_f32 v110, v110, v7
  v_mul_f32 v111, v111, v7
  v_mul_f32 v112, v112, v7
  v_mul_f32 v113, v113, v7
  v_mul_f32 v114, v114, v7
  v_mul_f32 v115, v115, v7
  v_mul_f32 v116, v116, v7
  v_mul_f32 v117, v117, v7
  v_mul_f32 v118, v118, v7
  v_mul_f32 v119, v119, v7
  v_mul_f32 v120, v120, v7
  v_mul_f32 v121, v121, v7
  v_mul_f32 v122, v122, v7
  v_mul_f32 v123, v123, v7
  v_mul_f32 v124, v124, v7
  v_mul_f32 v125, v125, v7
  v_mul_f32 v126, v126, v7
  v_mul_f32 v127, v127, v7
  v_mul_f32 v128, v128, v7
  v_mul_f32 v129, v129, v7
  v_mul_f32 v130, v130, v7
  v_mul_f32 v131, v131, v7
  v_mul_f32 v132, v132, v7
  v_mul_f32 v133, v133, v7
  v_mul_f32 v134, v134, v7
  v_mul_f32 v135, v135, v7
  v_mul_f32 v136, v136, v7
  v_mul_f32 v137, v137, v7
  v_mul_f32 v138, v138, v7
  v_mul_f32 v139, v139, v7
  v_cvt_pk_bf16_f32 v16, v100, v101
  v_cvt_pk_bf16_f32 v17, v102, v103
  v_cvt_pk_bf16_f32 v18, v104, v105
  v_cvt_pk_bf16_f32 v19, v106, v107
  ds_write_b128 v10, v[16:19] offset:0
  v_cvt_pk_bf16_f32 v20, v108, v109
  v_cvt_pk_bf16_f32 v21, v110, v111
  v_cvt_pk_bf16_f32 v22, v112, v113
  v_cvt_pk_bf16_f32 v23, v114, v115
  ds_write_b128 v10, v[20:23] offset:256
  v_cvt_pk_bf16_f32 v24, v116, v117
  v_cvt_pk_bf16_f32 v25, v118, v119
  v_cvt_pk_bf16_f32 v26, v120, v121
  v_cvt_pk_bf16_f32 v27, v122, v123
  ds_write_b128 v10, v[24:27] offset:512
  v_cvt_pk_bf16_f32 v28, v124, v125
  v_cvt_pk_bf16_f32 v29, v126, v127
  v_cvt_pk_bf16_f32 v30, v128, v129
  v_cvt_pk_bf16_f32 v31, v130, v131
  ds_write_b128 v10, v[28:31] offset:768
  v_cvt_pk_bf16_f32 v32, v132, v133
  v_cvt_pk_bf16_f32 v33, v134, v135
  v_cvt_pk_bf16_f32 v34, v136, v137
  v_cvt_pk_bf16_f32 v35, v138, v139
  ds_write_b128 v10, v[32:35] offset:1024
  s_waitcnt lgkmcnt(0)
  s_barrier
  ds_read_b64_tr_b16 v[140:141], v11 offset:0
  ds_read_b64_tr_b16 v[142:143], v11 offset:5376
  ds_read_b64_tr_b16 v[144:145], v11 offset:128
  ds_read_b64_tr_b16 v[146:147], v11 offset:5504
  ds_read_b64_tr_b16 v[148:149], v11 offset:256
  ds_read_b64_tr_b16 v[150:151], v11 offset:5632
  ds_read_b64_tr_b16 v[152:153], v11 offset:384
  ds_read_b64_tr_b16 v[154:155], v11 offset:5760
  ds_read_b64_tr_b16 v[156:157], v11 offset:512
  ds_read_b64_tr_b16 v[158:159], v11 offset:5888
  s_lshl_b32 s48, s50, 8
  v_add_u32 v14, s48, v12
  s_waitcnt lgkmcnt(8)
  s_mov_b32 s48, 0
  buffer_store_dwordx4 v[140:143], v14, s[32:35], s48 offen sc1
  s_waitcnt lgkmcnt(6)
  s_mov_b32 s48, 262144
  buffer_store_dwordx4 v[144:147], v14, s[32:35], s48 offen sc1
  s_waitcnt lgkmcnt(4)
  s_mov_b32 s48, 524288
  buffer_store_dwordx4 v[148:151], v14, s[32:35], s48 offen sc1
  s_waitcnt lgkmcnt(2)
  s_mov_b32 s48, 786432
  buffer_store_dwordx4 v[152:155], v14, s[32:35], s48 offen sc1
  s_waitcnt lgkmcnt(0)
  s_mov_b32 s48, 1048576
  buffer_store_dwordx4 v[156:159], v14, s[32:35], s48 offen sc1
  s_cmp_ge_u32 s46, 32
  s_cbranch_scc1 Lax_69
  s_barrier
  v_lshlrev_b32 v100, 16, v36
  v_and_b32 v101, 0xffff0000, v36
  v_lshlrev_b32 v102, 16, v37
  v_and_b32 v103, 0xffff0000, v37
  v_lshlrev_b32 v104, 16, v38
  v_and_b32 v105, 0xffff0000, v38
  v_lshlrev_b32 v106, 16, v39
  v_and_b32 v107, 0xffff0000, v39
  v_lshlrev_b32 v108, 16, v40
  v_and_b32 v109, 0xffff0000, v40
  v_lshlrev_b32 v110, 16, v41
  v_and_b32 v111, 0xffff0000, v41
  v_lshlrev_b32 v112, 16, v42
  v_and_b32 v113, 0xffff0000, v42
  v_lshlrev_b32 v114, 16, v43
  v_and_b32 v115, 0xffff0000, v43
  v_lshlrev_b32 v116, 16, v44
  v_and_b32 v117, 0xffff0000, v44
  v_lshlrev_b32 v118, 16, v45
  v_and_b32 v119, 0xffff0000, v45
  v_lshlrev_b32 v120, 16, v46
  v_and_b32 v121, 0xffff0000, v46
  v_lshlrev_b32 v122, 16, v47
  v_and_b32 v123, 0xffff0000, v47
  v_lshlrev_b32 v124, 16, v48
  v_and_b32 v125, 0xffff0000, v48
  v_lshlrev_b32 v126, 16, v49
  v_and_b32 v127, 0xffff0000, v49
  v_lshlrev_b32 v128, 16, v50
  v_and_b32 v129, 0xffff0000, v50
  v_lshlrev_b32 v130, 16, v51
  v_and_b32 v131, 0xffff0000, v51
  v_lshlrev_b32 v132, 16, v52
  v_and_b32 v133, 0xffff0000, v52
  v_lshlrev_b32 v134, 16, v53
  v_and_b32 v135, 0xffff0000, v53
  v_lshlrev_b32 v136, 16, v54
  v_and_b32 v137, 0xffff0000, v54
  v_lshlrev_b32 v138, 16, v55
  v_and_b32 v139, 0xffff0000, v55
  v_add_f32 v8, v100, v102
  v_add_f32 v9, v101, v103
  v_add_f32 v8, v8, v104
  v_add_f32 v9, v9, v105
  v_add_f32 v8, v8, v106
  v_add_f32 v9, v9, v107
  v_add_f32 v8, v8, v108
  v_add_f32 v9, v9, v109
  v_add_f32 v8, v8, v110
  v_add_f32 v9, v9, v111
  v_add_f32 v8, v8, v112
  v_add_f32 v9, v9, v113
  v_add_f32 v8, v8, v114
  v_add_f32 v9, v9, v115
  v_add_f32 v8, v8, v116
  v_add_f32 v9, v9, v117
  v_add_f32 v8, v8, v118
  v_add_f32 v9, v9, v119
  v_add_f32 v8, v8, v120
  v_add_f32 v9, v9, v121
  v_add_f32 v8, v8, v122
  v_add_f32 v9, v9, v123
  v_add_f32 v8, v8, v124
  v_add_f32 v9, v9, v125
  v_add_f32 v8, v8, v126
  v_add_f32 v9, v9, v127
  v_add_f32 v8, v8, v128
  v_add_f32 v9, v9, v129
  v_add_f32 v8, v8, v130
  v_add_f32 v9, v9, v131
  v_add_f32 v8, v8, v132
  v_add_f32 v9, v9, v133
  v_add_f32 v8, v8, v134
  v_add_f32 v9, v9, v135
  v_add_f32 v8, v8, v136
  v_add_f32 v9, v9, v137
  v_add_f32 v8, v8, v138
  v_add_f32 v9, v9, v139
  v_add_f32 v6, v8, v9
  s_nop 1
  v_add_f32_dpp v6, v6, v6 row_ror:8 row_mask:0xf bank_mask:0xf
  s_nop 1
  v_add_f32_dpp v6, v6, v6 row_ror:4 row_mask:0xf bank_mask:0xf
  s_nop 1
  v_add_f32_dpp v6, v6, v6 row_ror:2 row_mask:0xf bank_mask:0xf
  s_nop 1
  v_add_f32_dpp v6, v6, v6 row_ror:1 row_mask:0xf bank_mask:0xf
  v_mul_f32 v6, 0x3acccccd, v6
  v_sub_f32 v100, v100, v6
  v_sub_f32 v101, v101, v6
  v_sub_f32 v102, v102, v6
  v_sub_f32 v103, v103, v6
  v_sub_f32 v104, v104, v6
  v_sub_f32 v105, v105, v6
  v_sub_f32 v106, v106, v6
  v_sub_f32 v107, v107, v6
  v_sub_f32 v108, v108, v6
  v_sub_f32 v109, v109, v6
  v_sub_f32 v110, v110, v6
  v_sub_f32 v111, v111, v6
  v_sub_f32 v112, v112, v6
  v_sub_f32 v113, v113, v6
  v_sub_f32 v114, v114, v6
  v_sub_f32 v115, v115, v6
  v_sub_f32 v116, v116, v6
  v_sub_f32 v117, v117, v6
  v_sub_f32 v118, v118, v6
  v_sub_f32 v119, v119, v6
  v_sub_f32 v120, v120, v6
  v_sub_f32 v121, v121, v6
  v_sub_f32 v122, v122, v6
  v_sub_f32 v123, v123, v6
  v_sub_f32 v124, v124, v6
  v_sub_f32 v125, v125, v6
  v_sub_f32 v126, v126, v6
  v_sub_f32 v127, v127, v6
  v_sub_f32 v128, v128, v6
  v_sub_f32 v129, v129, v6
  v_sub_f32 v130, v130, v6
  v_sub_f32 v131, v131, v6
  v_sub_f32 v132, v132, v6
  v_sub_f32 v133, v133, v6
  v_sub_f32 v134, v134, v6
  v_sub_f32 v135, v135, v6
  v_sub_f32 v136, v136, v6
  v_sub_f32 v137, v137, v6
  v_sub_f32 v138, v138, v6
  v_sub_f32 v139, v139, v6
  v_mul_f32 v8, v100, v100
  v_mul_f32 v9, v101, v101
  v_fmac_f32 v8, v102, v102
  v_fmac_f32 v9, v103, v103
  v_fmac_f32 v8, v104, v104
  v_fmac_f32 v9, v105, v105
  v_fmac_f32 v8, v106, v106
  v_fmac_f32 v9, v107, v107
  v_fmac_f32 v8, v108, v108
  v_fmac_f32 v9, v109, v109
  v_fmac_f32 v8, v110, v110
  v_fmac_f32 v9, v111, v111
  v_fmac_f32 v8, v112, v112
  v_fmac_f32 v9, v113, v113
  v_fmac_f32 v8, v114, v114
  v_fmac_f32 v9, v115, v115
  v_fmac_f32 v8, v116, v116
  v_fmac_f32 v9, v117, v117
  v_fmac_f32 v8, v118, v118
  v_fmac_f32 v9, v119, v119
  v_fmac_f32 v8, v120, v120
  v_fmac_f32 v9, v121, v121
  v_fmac_f32 v8, v122, v122
  v_fmac_f32 v9, v123, v123
  v_fmac_f32 v8, v124, v124
  v_fmac_f32 v9, v125, v125
  v_fmac_f32 v8, v126, v126
  v_fmac_f32 v9, v127, v127
  v_fmac_f32 v8, v128, v128
  v_fmac_f32 v9, v129, v129
  v_fmac_f32 v8, v130, v130
  v_fmac_f32 v9, v131, v131
  v_fmac_f32 v8, v132, v132
  v_fmac_f32 v9, v133, v133
  v_fmac_f32 v8, v134, v134
  v_fmac_f32 v9, v135, v135
  v_fmac_f32 v8, v136, v136
  v_fmac_f32 v9, v137, v137
  v_fmac_f32 v8, v138, v138
  v_fmac_f32 v9, v139, v139
  v_add_f32 v7, v8, v9
  s_nop 1
  v_add_f32_dpp v7, v7, v7 row_ror:8 row_mask:0xf bank_mask:0xf
  s_nop 1
  v_add_f32_dpp v7, v7, v7 row_ror:4 row_mask:0xf bank_mask:0xf
  s_nop 1
  v_add_f32_dpp v7, v7, v7 row_ror:2 row_mask:0xf bank_mask:0xf
  s_nop 1
  v_add_f32_dpp v7, v7, v7 row_ror:1 row_mask:0xf bank_mask:0xf
  v_mul_f32 v7, 0x3acccccd, v7
  v_cvt_pk_bf16_f32 v7, v7, v7
  v_and_b32 v7, 0xffff0000, v7
  v_add_f32 v7, 0x3727c5ac, v7
  v_cvt_pk_bf16_f32 v7, v7, v7
  v_and_b32 v7, 0xffff0000, v7
  v_sqrt_f32 v7, v7
  s_nop 0
  v_cvt_pk_bf16_f32 v7, v7, v7
  v_and_b32 v7, 0xffff0000, v7
  v_rcp_f32 v7, v7
  v_cvt_pk_bf16_f32 v160, v6, v6
  v_and_b32 v160, 0xffff0000, v160
  v_xor_b32 v160, 0x80000000, v160
  v_mov_b32 v161, v7
  v_mov_b32 v162, s40
  v_mov_b32 v163, s40
  v_lshrrev_b32 v4, 4, v1
  v_lshl_add_u32 v4, v2, 2, v4
  v_lshlrev_b32 v13, 4, v4
  s_lshl_b32 s48, s51, 8
  s_add_u32 s48, s48, 14155776
  s_mov_b32 exec_lo, 0x00010001
  s_mov_b32 exec_hi, 0x00010001
  buffer_store_dwordx4 v[160:163], v13, s[32:35], s48 offen sc1
  s_mov_b64 exec, -1
  v_mul_f32 v100, v100, v7
  v_mul_f32 v101, v101, v7
  v_mul_f32 v102, v102, v7
  v_mul_f32 v103, v103, v7
  v_mul_f32 v104, v104, v7
  v_mul_f32 v105, v105, v7
  v_mul_f32 v106, v106, v7
  v_mul_f32 v107, v107, v7
  v_mul_f32 v108, v108, v7
  v_mul_f32 v109, v109, v7
  v_mul_f32 v110, v110, v7
  v_mul_f32 v111, v111, v7
  v_mul_f32 v112, v112, v7
  v_mul_f32 v113, v113, v7
  v_mul_f32 v114, v114, v7
  v_mul_f32 v115, v115, v7
  v_mul_f32 v116, v116, v7
  v_mul_f32 v117, v117, v7
  v_mul_f32 v118, v118, v7
  v_mul_f32 v119, v119, v7
  v_mul_f32 v120, v120, v7
  v_mul_f32 v121, v121, v7
  v_mul_f32 v122, v122, v7
  v_mul_f32 v123, v123, v7
  v_mul_f32 v124, v124, v7
  v_mul_f32 v125, v125, v7
  v_mul_f32 v126, v126, v7
  v_mul_f32 v127, v127, v7
  v_mul_f32 v128, v128, v7
  v_mul_f32 v129, v129, v7
  v_mul_f32 v130, v130, v7
  v_mul_f32 v131, v131, v7
  v_mul_f32 v132, v132, v7
  v_mul_f32 v133, v133, v7
  v_mul_f32 v134, v134, v7
  v_mul_f32 v135, v135, v7
  v_mul_f32 v136, v136, v7
  v_mul_f32 v137, v137, v7
  v_mul_f32 v138, v138, v7
  v_mul_f32 v139, v139, v7
  v_cvt_pk_bf16_f32 v36, v100, v101
  v_cvt_pk_bf16_f32 v37, v102, v103
  v_cvt_pk_bf16_f32 v38, v104, v105
  v_cvt_pk_bf16_f32 v39, v106, v107
  ds_write_b128 v10, v[36:39] offset:0
  v_cvt_pk_bf16_f32 v40, v108, v109
  v_cvt_pk_bf16_f32 v41, v110, v111
  v_cvt_pk_bf16_f32 v42, v112, v113
  v_cvt_pk_bf16_f32 v43, v114, v115
  ds_write_b128 v10, v[40:43] offset:256
  v_cvt_pk_bf16_f32 v44, v116, v117
  v_cvt_pk_bf16_f32 v45, v118, v119
  v_cvt_pk_bf16_f32 v46, v120, v121
  v_cvt_pk_bf16_f32 v47, v122, v123
  ds_write_b128 v10, v[44:47] offset:512
  v_cvt_pk_bf16_f32 v48, v124, v125
  v_cvt_pk_bf16_f32 v49, v126, v127
  v_cvt_pk_bf16_f32 v50, v128, v129
  v_cvt_pk_bf16_f32 v51, v130, v131
  ds_write_b128 v10, v[48:51] offset:768
  v_cvt_pk_bf16_f32 v52, v132, v133
  v_cvt_pk_bf16_f32 v53, v134, v135
  v_cvt_pk_bf16_f32 v54, v136, v137
  v_cvt_pk_bf16_f32 v55, v138, v139
  ds_write_b128 v10, v[52:55] offset:1024
  s_waitcnt lgkmcnt(0)
  s_barrier
  ds_read_b64_tr_b16 v[140:141], v11 offset:0
  ds_read_b64_tr_b16 v[142:143], v11 offset:5376
  ds_read_b64_tr_b16 v[144:145], v11 offset:128
  ds_read_b64_tr_b16 v[146:147], v11 offset:5504
  ds_read_b64_tr_b16 v[148:149], v11 offset:256
  ds_read_b64_tr_b16 v[150:151], v11 offset:5632
  ds_read_b64_tr_b16 v[152:153], v11 offset:384
  ds_read_b64_tr_b16 v[154:155], v11 offset:5760
  ds_read_b64_tr_b16 v[156:157], v11 offset:512
  ds_read_b64_tr_b16 v[158:159], v11 offset:5888
  s_lshl_b32 s48, s51, 8
  v_add_u32 v14, s48, v12
  s_waitcnt lgkmcnt(8)
  s_mov_b32 s48, 0
  buffer_store_dwordx4 v[140:143], v14, s[32:35], s48 offen sc1
  s_waitcnt lgkmcnt(6)
  s_mov_b32 s48, 262144
  buffer_store_dwordx4 v[144:147], v14, s[32:35], s48 offen sc1
  s_waitcnt lgkmcnt(4)
  s_mov_b32 s48, 524288
  buffer_store_dwordx4 v[148:151], v14, s[32:35], s48 offen sc1
  s_waitcnt lgkmcnt(2)
  s_mov_b32 s48, 786432
  buffer_store_dwordx4 v[152:155], v14, s[32:35], s48 offen sc1
  s_waitcnt lgkmcnt(0)
  s_mov_b32 s48, 1048576
  buffer_store_dwordx4 v[156:159], v14, s[32:35], s48 offen sc1
Lax_69:
  s_waitcnt vmcnt(0)
  s_barrier
  s_lshl_b32 s48, s50, 6
  s_add_u32 s48, s48, 14761984
  v_cmp_eq_u32 vcc, 0, v0
  s_nop 3
  s_and_saveexec_b64 s[42:43], vcc
  s_cbranch_execz Lfs_70
  v_mov_b32 v4, 0
  v_mov_b32 v5, s40
  buffer_store_dword v5, v4, s[32:35], s48 offen sc1
Lfs_70:
  s_mov_b64 exec, s[42:43]
  s_cmp_ge_u32 s46, 32
  s_cbranch_scc1 Lax_71
  s_lshl_b32 s48, s51, 6
  s_add_u32 s48, s48, 14761984
  v_cmp_eq_u32 vcc, 0, v0
  s_nop 3
  s_and_saveexec_b64 s[42:43], vcc
  s_cbranch_execz Lfs_72
  v_mov_b32 v4, 0
  v_mov_b32 v5, s40
  buffer_store_dword v5, v4, s[32:35], s48 offen sc1
Lfs_72:
  s_mov_b64 exec, s[42:43]
Lax_71:
  s_setprio 0
  v_lshrrev_b32 v4, 4, v1
  v_lshlrev_b32 v60, 3, v4
  v_bfe_u32 v5, v1, 2, 2
  v_add_u32 v60, v60, v5
  v_lshlrev_b32 v60, 7, v60
  v_and_b32 v5, 3, v1
  v_lshl_add_u32 v60, v5, 3, v60
  v_add_u32 v60, s62, v60
  v_lshlrev_b32 v61, 4, v1
  s_mul_i32 s66, s65, 196608
  s_lshl_b32 s67, s64, 10
  s_add_u32 s66, s66, s67
  s_add_u32 s66, s66, 9437184
  ds_read_b64_tr_b16 v[64:65], v60 offset:0
  ds_read_b64_tr_b16 v[66:67], v60 offset:512
  ds_read_b64_tr_b16 v[68:69], v60 offset:32
  ds_read_b64_tr_b16 v[70:71], v60 offset:544
  ds_read_b64_tr_b16 v[72:73], v60 offset:64
  ds_read_b64_tr_b16 v[74:75], v60 offset:576
  ds_read_b64_tr_b16 v[76:77], v60 offset:96
  ds_read_b64_tr_b16 v[78:79], v60 offset:608
  s_waitcnt lgkmcnt(6)
  buffer_store_dwordx4 v[64:67], v61, s[32:35], s66 offen sc1
  s_add_u32 s66, s66, 49152
  s_waitcnt lgkmcnt(4)
  buffer_store_dwordx4 v[68:71], v61, s[32:35], s66 offen sc1
  s_add_u32 s66, s66, 49152
  s_waitcnt lgkmcnt(2)
  buffer_store_dwordx4 v[72:75], v61, s[32:35], s66 offen sc1
  s_add_u32 s66, s66, 49152
  s_waitcnt lgkmcnt(0)
  buffer_store_dwordx4 v[76:79], v61, s[32:35], s66 offen sc1
  s_cmp_lt_u32 s60, 288
  s_cbranch_scc1 Lax_73
  v_lshrrev_b32 v4, 4, v1
  v_lshlrev_b32 v60, 3, v4
  v_bfe_u32 v5, v1, 2, 2
  v_add_u32 v60, v60, v5
  v_lshlrev_b32 v60, 7, v60
  v_and_b32 v5, 3, v1
  v_lshl_add_u32 v60, v5, 3, v60
  v_add_u32 v60, s63, v60
  v_lshlrev_b32 v61, 4, v1
  s_mul_i32 s70, s69, 196608
  s_lshl_b32 s71, s68, 10
  s_add_u32 s70, s70, s71
  s_add_u32 s70, s70, 9437184
  ds_read_b64_tr_b16 v[80:81], v60 offset:0
  ds_read_b64_tr_b16 v[82:83], v60 offset:512
  ds_read_b64_tr_b16 v[84:85], v60 offset:32
  ds_read_b64_tr_b16 v[86:87], v60 offset:544
  ds_read_b64_tr_b16 v[88:89], v60 offset:64
  ds_read_b64_tr_b16 v[90:91], v60 offset:576
  ds_read_b64_tr_b16 v[92:93], v60 offset:96
  ds_read_b64_tr_b16 v[94:95], v60 offset:608
  s_waitcnt lgkmcnt(6)
  buffer_store_dwordx4 v[80:83], v61, s[32:35], s70 offen sc1
  s_add_u32 s70, s70, 49152
  s_waitcnt lgkmcnt(4)
  buffer_store_dwordx4 v[84:87], v61, s[32:35], s70 offen sc1
  s_add_u32 s70, s70, 49152
  s_waitcnt lgkmcnt(2)
  buffer_store_dwordx4 v[88:91], v61, s[32:35], s70 offen sc1
  s_add_u32 s70, s70, 49152
  s_waitcnt lgkmcnt(0)
  buffer_store_dwordx4 v[92:95], v61, s[32:35], s70 offen sc1
Lax_73:
  s_waitcnt vmcnt(0)
  s_barrier
  s_lshl_b32 s48, s46, 6
  s_add_u32 s48, s48, 14712832
  v_cmp_eq_u32 vcc, 0, v0
  s_nop 3
  s_and_saveexec_b64 s[42:43], vcc
  s_cbranch_execz Lfs_74
  v_mov_b32 v4, 0
  v_mov_b32 v5, s40
  buffer_store_dword v5, v4, s[32:35], s48 offen sc1
Lfs_74:
  s_mov_b64 exec, s[42:43]
Lend:
  s_endpgm
Lcode_end:
.section .rodata,"a"
.p2align 6
.amdhsa_kernel parallel_sum__ssm_conv_s4d__glu_gated_swiglu__prompt_kernel
  .amdhsa_next_free_vgpr 256
  .amdhsa_next_free_sgpr 102
  .amdhsa_accum_offset 256
  .amdhsa_group_segment_fixed_size 0
  .amdhsa_kernarg_size 112
  .amdhsa_user_sgpr_count 2
  .amdhsa_user_sgpr_kernarg_segment_ptr 1
  .amdhsa_system_sgpr_workgroup_id_x 1
  .amdhsa_float_denorm_mode_32 3
.end_amdhsa_kernel
```
